```python
import torch

def _softmax(x, axis=-1):
    return torch.softmax(x, dim=axis)
def _gelu(x):
    return torch.nn.functional.gelu(x, approximate="tanh")
def _silu(x):
    return torch.nn.functional.silu(x)
def _sigmoid(x):
    return torch.sigmoid(x)
def _layernorm(x, axis=-1, eps=1e-5):
    m = x.mean(dim=axis, keepdim=True)
    v = x.var(dim=axis, keepdim=True, unbiased=False)
    return (x - m) / torch.sqrt(v + eps)
def _scatter_add(tgt, idx, src, axis=0):
    return tgt.clone().index_add_(axis, idx, src)
def _segment_sum(src, seg, n):
    out = torch.zeros((n,) + src.shape[1:], dtype=src.dtype)
    return out.index_add_(0, seg, src)
def _pad(x, pw):
    flat = tuple(v for pair in reversed(pw) for v in pair)
    return torch.nn.functional.pad(x, flat)

kernel_name = 'sequential_preLN__ssm_conv_h3__swiglu_ffn__prompt'

def setup_inputs():

    _w = (lambda a: (lambda t: t.to(torch.bfloat16) if t.is_floating_point() else t)(torch.as_tensor(a)))
    def _A_setup():
        B, S, D = 1, 2048, 512
        ks = 4
        return {
            "q": _w((lambda *s: torch.randn(*s, dtype=torch.bfloat16) * 0.05)(B, S, D)),
            "k": _w((lambda *s: torch.randn(*s, dtype=torch.bfloat16) * 0.4)(B, S, D)),
            "v": _w((lambda *s: torch.randn(*s, dtype=torch.bfloat16) * 0.4)(B, S, D)),
            "shift_k": _w((lambda *s: torch.randn(*s, dtype=torch.bfloat16) * 0.4)(D, ks) * 0.5),
            "ssm_k": _w((lambda *s: torch.randn(*s, dtype=torch.bfloat16) * 0.4)(D, S) * (1.0 / S ** 0.5)),
            "ssm_D": _w((lambda *s: torch.randn(*s, dtype=torch.bfloat16) * 0.4)(D)),
        }
    _A_in = _A_setup()

    def _B_setup():
        B, S, D, F = 1, 2048, 512, 1792
        return {
            "x": _w((lambda *s: torch.randn(*s, dtype=torch.bfloat16) * 0.05)(B, S, D)),
            "w_gate": _w((lambda *s: torch.randn(*s, dtype=torch.bfloat16) * 0.05)(D, F)),
            "w_up": _w((lambda *s: torch.randn(*s, dtype=torch.bfloat16) * 0.05)(D, F)),
            "w_down": _w((lambda *s: torch.randn(*s, dtype=torch.bfloat16) * 0.05)(F, D)),
        }
    _B_in = _B_setup()

    return {
        "A_q": _A_in["q"],
        "A_k": _A_in["k"],
        "A_v": _A_in["v"],
        "A_shift_k": _A_in["shift_k"],
        "A_ssm_k": _A_in["ssm_k"],
        "A_ssm_D": _A_in["ssm_D"],
        "B_x": _B_in["x"],
        "B_w_gate": _B_in["w_gate"],
        "B_w_up": _B_in["w_up"],
        "B_w_down": _B_in["w_down"],
    }

def reference(A_q, A_k, A_v, A_shift_k, A_ssm_k, A_ssm_D, B_x, B_w_gate, B_w_up, B_w_down):
    def _A_ref(q, k, v, shift_k, ssm_k, ssm_D):
        B, S, D = q.shape
        ks = shift_k.shape[-1]
        k_pad = _pad(k, ((0, 0), (ks - 1, 0), (0, 0)))
        k_shift = torch.zeros_like(k)
        for t in range(ks):
            k_shift = k_shift + k_pad[:, t:t + S, :] * shift_k[:, ks - 1 - t][None, None, :]
        kv = k_shift * v
        L = 2 * S
        kv_pad = _pad(kv, ((0, 0), (0, S), (0, 0)))
        kf_pad = _pad(ssm_k, ((0, 0), (0, S)))
        kv_f = (lambda x, axes=(-2,-1): torch.fft.rfft2(x.float(), dim=axes))(kv_pad[:, None, :, :], axes=(1, 2))
        kf_f = (lambda x, axes=(-2,-1): torch.fft.rfft2(x.float(), dim=axes))(kf_pad[:, None, :], axes=(1, 2))
        kf_f = (lambda x, *d: x.permute(*d))(kf_f, 1, 2, 0)
        y_f = kv_f * kf_f[None, :, :, :]
        y = (lambda x, s, axes=(-2,-1): torch.fft.irfft2(x, s=s, dim=axes).to(torch.bfloat16))(y_f, (1, L), axes=(1, 2))[:, 0, :S, :]
        y = y + kv * ssm_D[None, None, :]
        return q * y

    def _B_ref(x, w_gate, w_up, w_down):
        g = _silu(x @ w_gate)
        u = x @ w_up
        return (g * u) @ w_down

    x = A_q
    h = x + _A_ref(_layernorm(x, axis=-1), A_k, A_v, A_shift_k, A_ssm_k, A_ssm_D)
    h2 = h + _B_ref(_layernorm(h, axis=-1), B_w_gate, B_w_up, B_w_down)
    return h2
```

```asm
; @launch kernel=prep_kernel grid=(256,1,1) block=(512,1,1) lds=0
; @launch kernel=conv_kernel grid=(256,1,1) block=(512,1,1) lds=121856
; @launch kernel=ffn_kernel grid=(256,1,1) block=(512,1,1) lds=163328
.amdgcn_target "amdgcn-amd-amdhsa--gfx950"
.text
.globl prep_kernel
.p2align 8
.type prep_kernel,@function
prep_kernel:
    s_cmp_ge_u32 s2, 256
    s_cbranch_scc1 prep_end
    s_load_dwordx8 s[4:11], s[0:1], 0
    s_load_dwordx2 s[12:13], s[0:1], 96
    v_lshrrev_b32 v1, 8, v0
    v_and_b32 v4, 31, v0
    v_readfirstlane_b32 s53, v1
    v_bfe_u32 v5, v0, 5, 3
    s_and_b32 s14, s2, 7
    s_lshr_b32 s15, s2, 3
    s_mov_b32 s50, 0xffff0000
    s_cmp_eq_u32 s53, 1
    s_cbranch_scc1 prep_x
    s_lshl_b32 s44, s15, 16
    s_lshl_b32 s45, s14, 7
    s_add_u32 s44, s44, s45
    v_lshlrev_b32 v2, 13, v5
    v_lshl_add_u32 v2, v4, 2, v2
    v_add_u32 v2, s44, v2
    v_add_u32 v3, 0x1000, v2
    v_subrev_u32 v1, 0x1000, v2
    s_lshl_b32 s48, s14, 9
    v_lshlrev_b32 v6, 4, v4
    v_add_u32 v6, s48, v6
    s_waitcnt lgkmcnt(0)
    s_mov_b32 s20, s6
    s_mov_b32 s21, s7
    s_mov_b32 s22, 0x200000
    s_mov_b32 s23, 0x20000
    buffer_load_dword v10, v1, s[20:23], 0 offen offset:1024
    buffer_load_dword v11, v1, s[20:23], 0 offen offset:2048
    buffer_load_dword v12, v1, s[20:23], 0 offen offset:3072
    buffer_load_dword v13, v2, s[20:23], 0 offen offset:0
    buffer_load_dword v14, v2, s[20:23], 0 offen offset:1024
    buffer_load_dword v15, v2, s[20:23], 0 offen offset:2048
    buffer_load_dword v16, v2, s[20:23], 0 offen offset:3072
    buffer_load_dword v17, v3, s[20:23], 0 offen offset:0
    buffer_load_dword v18, v3, s[20:23], 0 offen offset:1024
    buffer_load_dword v19, v3, s[20:23], 0 offen offset:2048
    buffer_load_dword v20, v3, s[20:23], 0 offen offset:3072
    s_mov_b32 s28, s10
    s_mov_b32 s29, s11
    s_mov_b32 s30, 0x1000
    s_mov_b32 s31, 0x20000
    buffer_load_dwordx4 v[32:35], v6, s[28:31], 0 offen
    s_mov_b32 s24, s8
    s_mov_b32 s25, s9
    s_mov_b32 s26, 0x200000
    s_mov_b32 s27, 0x20000
    buffer_load_dword v22, v2, s[24:27], 0 offen offset:0
    buffer_load_dword v23, v2, s[24:27], 0 offen offset:1024
    buffer_load_dword v24, v2, s[24:27], 0 offen offset:2048
    buffer_load_dword v25, v2, s[24:27], 0 offen offset:3072
    buffer_load_dword v26, v3, s[24:27], 0 offen offset:0
    buffer_load_dword v27, v3, s[24:27], 0 offen offset:1024
    buffer_load_dword v28, v3, s[24:27], 0 offen offset:2048
    buffer_load_dword v29, v3, s[24:27], 0 offen offset:3072
    s_mov_b32 s32, s12
    s_mov_b32 s33, s13
    s_mov_b32 s34, 0x210000
    s_mov_b32 s35, 0x20000
    s_mov_b32 s47, 4224
    s_mul_i32 s45, s14, 270336
    s_lshl_b32 s46, s15, 7
    v_mul_u32_u24 v8, 8448, v4
    s_sub_u32 s45, s45, s46
    s_add_u32 s45, s45, 4080
    v_lshlrev_b32 v9, 4, v5
    v_sub_u32 v8, v8, v9
    v_add_u32 v8, s45, v8
    s_getpc_b64 s[54:55]
pf_here:
    s_add_u32 s54, s54, conv_kernel-pf_here
    s_addc_u32 s55, s55, 0
    s_lshl_b32 s56, s15, 10
    v_lshl_add_u32 v36, v5, 7, s56
    v_min_u32 v36, code_end-conv_kernel-4, v36
    v_mov_b32 v37, s55
    v_add_co_u32 v36, vcc, s54, v36
    s_nop 1
    v_addc_co_u32 v37, vcc, 0, v37, vcc
    global_load_dword v38, v[36:37], off
    s_waitcnt vmcnt(10)
    v_lshlrev_b32 v40, 16, v10
    v_and_b32 v41, s50, v10
    v_lshlrev_b32 v42, 16, v11
    v_and_b32 v43, s50, v11
    v_lshlrev_b32 v44, 16, v12
    v_and_b32 v45, s50, v12
    v_lshlrev_b32 v46, 16, v13
    v_and_b32 v47, s50, v13
    v_lshlrev_b32 v48, 16, v14
    v_and_b32 v49, s50, v14
    v_lshlrev_b32 v50, 16, v15
    v_and_b32 v51, s50, v15
    v_lshlrev_b32 v52, 16, v16
    v_and_b32 v53, s50, v16
    v_lshlrev_b32 v54, 16, v17
    v_and_b32 v55, s50, v17
    v_lshlrev_b32 v56, 16, v18
    v_and_b32 v57, s50, v18
    v_lshlrev_b32 v58, 16, v19
    v_and_b32 v59, s50, v19
    v_lshlrev_b32 v60, 16, v20
    v_and_b32 v61, s50, v20
    s_waitcnt vmcnt(9)
    v_lshlrev_b32 v64, 16, v32
    v_lshlrev_b32 v65, 16, v34
    v_and_b32 v66, s50, v32
    v_and_b32 v67, s50, v34
    v_lshlrev_b32 v68, 16, v33
    v_lshlrev_b32 v69, 16, v35
    v_and_b32 v70, s50, v33
    v_and_b32 v71, s50, v35
    v_pk_mul_f32 v[92:93], v[40:41], v[70:71]
    v_pk_mul_f32 v[94:95], v[42:43], v[70:71]
    v_pk_mul_f32 v[96:97], v[44:45], v[70:71]
    v_pk_mul_f32 v[98:99], v[46:47], v[70:71]
    v_pk_mul_f32 v[100:101], v[48:49], v[70:71]
    v_pk_mul_f32 v[102:103], v[50:51], v[70:71]
    v_pk_mul_f32 v[104:105], v[52:53], v[70:71]
    v_pk_mul_f32 v[106:107], v[54:55], v[70:71]
    v_pk_fma_f32 v[92:93], v[42:43], v[68:69], v[92:93]
    v_pk_fma_f32 v[94:95], v[44:45], v[68:69], v[94:95]
    v_pk_fma_f32 v[96:97], v[46:47], v[68:69], v[96:97]
    v_pk_fma_f32 v[98:99], v[48:49], v[68:69], v[98:99]
    v_pk_fma_f32 v[100:101], v[50:51], v[68:69], v[100:101]
    v_pk_fma_f32 v[102:103], v[52:53], v[68:69], v[102:103]
    v_pk_fma_f32 v[104:105], v[54:55], v[68:69], v[104:105]
    v_pk_fma_f32 v[106:107], v[56:57], v[68:69], v[106:107]
    v_pk_fma_f32 v[92:93], v[44:45], v[66:67], v[92:93]
    v_pk_fma_f32 v[94:95], v[46:47], v[66:67], v[94:95]
    v_pk_fma_f32 v[96:97], v[48:49], v[66:67], v[96:97]
    v_pk_fma_f32 v[98:99], v[50:51], v[66:67], v[98:99]
    v_pk_fma_f32 v[100:101], v[52:53], v[66:67], v[100:101]
    v_pk_fma_f32 v[102:103], v[54:55], v[66:67], v[102:103]
    v_pk_fma_f32 v[104:105], v[56:57], v[66:67], v[104:105]
    v_pk_fma_f32 v[106:107], v[58:59], v[66:67], v[106:107]
    v_pk_fma_f32 v[92:93], v[46:47], v[64:65], v[92:93]
    v_pk_fma_f32 v[94:95], v[48:49], v[64:65], v[94:95]
    v_pk_fma_f32 v[96:97], v[50:51], v[64:65], v[96:97]
    v_pk_fma_f32 v[98:99], v[52:53], v[64:65], v[98:99]
    v_pk_fma_f32 v[100:101], v[54:55], v[64:65], v[100:101]
    v_pk_fma_f32 v[102:103], v[56:57], v[64:65], v[102:103]
    v_pk_fma_f32 v[104:105], v[58:59], v[64:65], v[104:105]
    v_pk_fma_f32 v[106:107], v[60:61], v[64:65], v[106:107]
    s_waitcnt vmcnt(1)
    v_lshlrev_b32 v72, 16, v22
    v_and_b32 v73, s50, v22
    v_lshlrev_b32 v74, 16, v23
    v_and_b32 v75, s50, v23
    v_lshlrev_b32 v76, 16, v24
    v_and_b32 v77, s50, v24
    v_lshlrev_b32 v78, 16, v25
    v_and_b32 v79, s50, v25
    v_lshlrev_b32 v80, 16, v26
    v_and_b32 v81, s50, v26
    v_lshlrev_b32 v82, 16, v27
    v_and_b32 v83, s50, v27
    v_lshlrev_b32 v84, 16, v28
    v_and_b32 v85, s50, v28
    v_lshlrev_b32 v86, 16, v29
    v_and_b32 v87, s50, v29
    v_pk_mul_f32 v[92:93], v[92:93], v[72:73]
    v_pk_mul_f32 v[94:95], v[94:95], v[74:75]
    v_pk_mul_f32 v[96:97], v[96:97], v[76:77]
    v_pk_mul_f32 v[98:99], v[98:99], v[78:79]
    v_pk_mul_f32 v[100:101], v[100:101], v[80:81]
    v_pk_mul_f32 v[102:103], v[102:103], v[82:83]
    v_pk_mul_f32 v[104:105], v[104:105], v[84:85]
    v_pk_mul_f32 v[106:107], v[106:107], v[86:87]
    v_cvt_pk_bf16_f32 v112, v106, v104
    v_cvt_pk_bf16_f32 v113, v102, v100
    v_cvt_pk_bf16_f32 v114, v98, v96
    v_cvt_pk_bf16_f32 v115, v94, v92
    buffer_store_dwordx4 v[112:115], v8, s[32:35], 0 offen
    v_cvt_pk_bf16_f32 v116, v107, v105
    v_cvt_pk_bf16_f32 v117, v103, v101
    v_cvt_pk_bf16_f32 v118, v99, v97
    v_cvt_pk_bf16_f32 v119, v95, v93
    buffer_store_dwordx4 v[116:119], v8, s[32:35], s47 offen
    s_endpgm
prep_x:
    s_load_dwordx2 s[54:55], s[0:1], 32
    s_lshl_b32 s44, s14, 5
    s_add_u32 s44, s44, s15
    s_lshl_b32 s48, s44, 13
    s_add_u32 s49, s48, 4096
    v_lshlrev_b32 v7, 10, v5
    v_lshl_add_u32 v7, v4, 4, v7
    v_and_b32 v2, 255, v0
    v_lshlrev_b32 v3, 2, v2
    v_lshlrev_b32 v8, 7, v2
    s_lshr_b32 s45, s44, 2
    s_mul_i32 s45, s45, 32896
    s_and_b32 s46, s44, 3
    s_lshl_b32 s46, s46, 4
    s_add_u32 s45, s45, s46
    s_lshl_b32 s46, s44, 5
    s_add_u32 s46, s46, 4268032
    v_lshlrev_b32 v9, 2, v5
    v_lshl_add_u32 v9, v4, 13, v9
    s_mov_b32 s51, 0x05040100
    s_mov_b32 s52, 0x07060302
    s_waitcnt lgkmcnt(0)
    s_mov_b32 s16, s4
    s_mov_b32 s17, s5
    s_mov_b32 s18, 0x200000
    s_mov_b32 s19, 0x20000
    buffer_load_dwordx4 v[20:23], v7, s[16:19], s48 offen
    buffer_load_dwordx4 v[24:27], v7, s[16:19], s48 offen offset:512
    buffer_load_dword v10, v3, s[16:19], s48 offen offset:0
    buffer_load_dword v11, v3, s[16:19], s48 offen offset:1024
    buffer_load_dword v12, v3, s[16:19], s48 offen offset:2048
    buffer_load_dword v13, v3, s[16:19], s48 offen offset:3072
    buffer_load_dword v14, v3, s[16:19], s49 offen offset:0
    buffer_load_dword v15, v3, s[16:19], s49 offen offset:1024
    buffer_load_dword v16, v3, s[16:19], s49 offen offset:2048
    buffer_load_dword v17, v3, s[16:19], s49 offen offset:3072
    s_add_u32 s32, s12, 0x210000
    s_addc_u32 s33, s13, 0
    s_mov_b32 s34, 0x202000
    s_mov_b32 s35, 0x20000
    s_mov_b32 s40, s12
    s_mov_b32 s41, s13
    s_mov_b32 s42, 0x1286000
    s_mov_b32 s43, 0x20000
    v_mov_b32 v32, 0
    s_lshl_b32 s61, s2, 8
    s_add_u32 s61, s61, 4284416
    v_cmp_gt_u32 vcc, 64, v2
    v_mov_b32 v33, 0x7f000000
    s_nop 0
    v_cndmask_b32 v33, v33, v3, vcc
    s_lshr_b32 s62, s2, 4
    s_mul_i32 s62, s62, 237568
    s_and_b32 s63, s2, 15
    s_lshl_b32 s63, s63, 9
    s_add_u32 s62, s62, s63
    s_add_u32 s62, s62, 6675968
    v_cmp_lt_u32 vcc, 127, v2
    v_mov_b32 v34, 0x7f000000
    s_nop 0
    v_cndmask_b32 v34, v34, v3, vcc
    s_mov_b32 s20, s54
    s_mov_b32 s21, s55
    s_mov_b32 s22, 0x200000
    s_mov_b32 s23, 0x20000
    s_lshl_b32 s58, s14, 5
    s_add_u32 s58, s58, s15
    s_lshl_b32 s58, s58, 13
    v_lshrrev_b32 v30, 2, v2
    v_lshlrev_b32 v30, 7, v30
    buffer_load_dword v31, v30, s[20:23], s58 offen
    buffer_store_dword v32, v33, s[40:43], s61 offen
    buffer_store_dword v32, v34, s[40:43], s62 offen
    s_mov_b32 s63, 0x3f803f80
    v_mov_b32 v80, 0
    v_mov_b32 v81, 0
    v_mov_b32 v82, 0
    v_mov_b32 v83, 0
    s_waitcnt vmcnt(11)
    v_dot2c_f32_bf16 v80, s63, v20
    v_dot2c_f32_bf16 v82, v20, v20
    v_dot2c_f32_bf16 v81, s63, v21
    v_dot2c_f32_bf16 v83, v21, v21
    v_dot2c_f32_bf16 v80, s63, v22
    v_dot2c_f32_bf16 v82, v22, v22
    v_dot2c_f32_bf16 v81, s63, v23
    v_dot2c_f32_bf16 v83, v23, v23
    v_dot2c_f32_bf16 v80, s63, v24
    v_dot2c_f32_bf16 v82, v24, v24
    v_dot2c_f32_bf16 v81, s63, v25
    v_dot2c_f32_bf16 v83, v25, v25
    v_dot2c_f32_bf16 v80, s63, v26
    v_dot2c_f32_bf16 v82, v26, v26
    v_dot2c_f32_bf16 v81, s63, v27
    v_dot2c_f32_bf16 v83, v27, v27
    s_waitcnt vmcnt(3)
    v_perm_b32 v100, v11, v10, s51
    v_perm_b32 v101, v13, v12, s51
    v_perm_b32 v102, v15, v14, s51
    v_perm_b32 v103, v17, v16, s51
    buffer_store_dwordx4 v[100:103], v8, s[32:35], s45 offen offset:0
    v_perm_b32 v104, v11, v10, s52
    v_perm_b32 v105, v13, v12, s52
    v_perm_b32 v106, v15, v14, s52
    v_perm_b32 v107, v17, v16, s52
    buffer_store_dwordx4 v[104:107], v8, s[32:35], s45 offen offset:64
    v_add_f32 v80, v80, v81
    v_add_f32 v82, v82, v83
    s_nop 0
    v_add_f32_dpp v80, v80, v80 quad_perm:[1,0,3,2] row_mask:0xf bank_mask:0xf
    v_add_f32_dpp v82, v82, v82 quad_perm:[1,0,3,2] row_mask:0xf bank_mask:0xf
    s_nop 0
    v_add_f32_dpp v80, v80, v80 quad_perm:[2,3,0,1] row_mask:0xf bank_mask:0xf
    v_add_f32_dpp v82, v82, v82 quad_perm:[2,3,0,1] row_mask:0xf bank_mask:0xf
    s_nop 0
    v_add_f32_dpp v80, v80, v80 row_half_mirror row_mask:0xf bank_mask:0xf
    v_add_f32_dpp v82, v82, v82 row_half_mirror row_mask:0xf bank_mask:0xf
    s_nop 0
    v_add_f32_dpp v80, v80, v80 row_mirror row_mask:0xf bank_mask:0xf
    v_add_f32_dpp v82, v82, v82 row_mirror row_mask:0xf bank_mask:0xf
    v_mov_b32 v81, v80
    v_mov_b32 v83, v82
    s_nop 0
    v_permlane16_swap_b32 v80, v81
    v_permlane16_swap_b32 v82, v83
    v_add_f32 v80, v80, v81
    v_add_f32 v82, v82, v83
    v_mul_f32 v80, 0xbb000000, v80
    v_mul_f32 v82, 0x3b000000, v82
    v_fma_f32 v82, -v80, v80, v82
    v_max_f32 v82, 0, v82
    v_cvt_pk_bf16_f32 v80, v80, v80
    v_lshlrev_b32 v80, 16, v80
    v_cvt_pk_bf16_f32 v82, v82, v82
    v_lshlrev_b32 v82, 16, v82
    v_add_f32 v82, 0x3727c5ac, v82
    v_cvt_pk_bf16_f32 v82, v82, v82
    v_lshlrev_b32 v82, 16, v82
    v_sqrt_f32 v82, v82
    s_nop 0
    v_cvt_pk_bf16_f32 v82, v82, v82
    v_lshlrev_b32 v82, 16, v82
    v_rcp_f32 v84, v82
    s_nop 0
    v_mul_f32 v85, v80, v84
    s_mov_b32 vcc_lo, 0xaaaaaaaa
    s_mov_b32 vcc_hi, 0xaaaaaaaa
    v_cndmask_b32 v84, v84, v85, vcc
    s_mov_b32 exec_lo, 3
    s_mov_b32 exec_hi, 3
    buffer_store_dword v84, v9, s[40:43], s46 offen
prep_end:
    s_endpgm
.globl conv_kernel
.p2align 8
.type conv_kernel,@function
conv_kernel:
    s_cmp_ge_u32 s2, 256
    s_cbranch_scc1 conv_end
    s_load_dwordx4 s[4:7], s[0:1], 32
    s_load_dwordx2 s[14:15], s[0:1], 96
    v_lshrrev_b32 v1, 6, v0
    v_and_b32 v2, 63, v0
    v_readfirstlane_b32 s60, v1
    s_and_b32 s16, s2, 7
    s_lshr_b32 s17, s2, 3
    s_lshl_b32 s16, s16, 5
    s_add_u32 s16, s16, s17
    v_lshlrev_b32 v5, 3, v2
    v_lshlrev_b32 v6, 4, v2
    s_mov_b32 s93, 0x7f000000
    s_mov_b32 s94, 0
    s_bfe_u32 s61, s60, 0x10001
    s_and_b32 s62, s60, 1
    s_lshl_b32 s63, s16, 1
    s_add_u32 s63, s63, s61
    s_mul_i32 s70, s61, 18560
    s_mul_i32 s73, s63, 4224
    s_cmp_ge_u32 s60, 4
    s_cbranch_scc1 cv_help
    s_lshl_b32 s64, s63, 12
    s_lshl_b32 s65, s16, 2
    s_mul_i32 s66, s61, 8448
    s_add_u32 s66, s66, 37120
    s_xor_b32 s77, s62, 1
    s_lshl_b32 s69, s62, 11
    s_lshl_b32 s75, s62, 12
    v_and_b32 v8, 3, v2
    s_add_u32 s68, s66, s75
    v_lshl_add_u32 v57, v2, 5, s68
    s_barrier
    s_waitcnt lgkmcnt(0)
    s_add_u32 s24, s14, s73
    s_addc_u32 s25, s15, 0
    s_mov_b32 s26, 0x1000
    s_mov_b32 s27, 0x20000
    buffer_load_dwordx4 v[16:19], v6, s[24:27], s69 offen offset:0
    buffer_load_dwordx2 v[20:21], v6, s[24:27], s69 offen offset:16
    buffer_load_dwordx4 v[32:35], v6, s[24:27], s69 offen offset:1024
    buffer_load_dwordx2 v[36:37], v6, s[24:27], s69 offen offset:1040
    s_add_u32 s20, s4, s64
    s_addc_u32 s21, s5, 0
    s_mov_b32 s22, 0x1000
    s_mov_b32 s23, 0x20000
    buffer_load_dwordx4 v[48:51], v6, s[20:23], s69 offen offset:0
    buffer_load_dwordx4 v[52:55], v6, s[20:23], s69 offen offset:1024
    s_load_dword s67, s[6:7], s65
    s_barrier
    s_add_u32 s74, s69, s70
    v_add_u32 v56, s74, v6
    s_add_u32 s32, s14, 0x426000
    s_addc_u32 s33, s15, 0
    s_mov_b32 s34, 0x200000
    s_mov_b32 s35, 0x20000
    s_lshl_b32 s40, s62, 9
    s_lshl_b32 s50, s62, 18
    s_lshl_b32 s41, s77, 9
    s_lshl_b32 s51, s77, 18
    s_lshl_b32 s79, s63, 8
    s_add_u32 s50, s50, s79
    s_add_u32 s51, s51, s79
    s_add_u32 s51, s51, 0x80000
    s_add_u32 s52, s50, 0x100000
    s_add_u32 s53, s51, 0x100000
    v_and_b32 v12, 31, v2
    v_lshlrev_b32 v12, 3, v12
    s_and_b32 s74, s63, 3
    s_lshl_b32 s74, s74, 6
    v_xor_b32 v12, s74, v12
    v_lshrrev_b32 v13, 5, v2
    v_lshl_add_u32 v12, v13, 17, v12
    v_and_b32 v3, 15, v2
    v_lshrrev_b32 v4, 4, v2
    v_lshrrev_b32 v9, 2, v3
    v_mul_u32_u24 v10, 4640, v8
    v_lshlrev_b32 v9, 3, v9
    v_sub_u32 v9, v4, v9
    v_add_u32 v9, 24, v9
    v_lshl_add_u32 v224, v9, 4, v10
    s_lshl_b32 s88, s62, 8
    s_add_u32 s88, s88, s70
    v_add_u32 v224, s88, v224
    v_lshl_add_u32 v225, v4, 1, v3
    v_lshlrev_b32 v225, 4, v225
    s_lshl_b32 s89, s62, 9
    s_add_u32 s89, s89, s66
    s_add_u32 s89, s89, 16
    v_add_u32 v225, s89, v225
    s_lshl_b32 s88, s61, 6
    s_add_u32 s88, s88, 16384
    v_lshrrev_b32 v9, 3, v2
    v_lshlrev_b32 v9, 7, v9
    v_and_b32 v15, 7, v2
    v_lshl_add_u32 v9, v15, 3, v9
    s_sub_u32 s89, s70, s40
    s_add_u32 s89, s89, 14936
    v_sub_u32 v10, s89, v5
    s_lshl_b32 s89, s40, 1
    s_add_u32 s89, s89, 70400
    v_add_u32 v60, s89, v6
    s_add_u32 s89, s89, s88
    v_add_u32 v13, s89, v9
    s_sub_u32 s89, s70, s41
    s_add_u32 s89, s89, 14936
    v_sub_u32 v11, s89, v5
    s_lshl_b32 s89, s41, 1
    s_add_u32 s89, s89, 70400
    v_add_u32 v61, s89, v6
    s_add_u32 s89, s89, s88
    v_add_u32 v14, s89, v9
    s_lshl_b32 s90, s60, 12
    s_add_u32 s91, s90, 54016
    s_xor_b32 s90, s90, 0x1000
    s_add_u32 s90, s90, 54016
    v_add_u32 v62, s91, v6
    v_add_u32 v63, s90, v6
    s_mov_b32 s92, 0xffff0000
    v_lshlrev_b32 v15, 2, v8
    v_add_u32 v15, 119568, v15
    s_lshl_b32 s89, s60, 8
    s_add_u32 s89, s89, 119808
    v_lshl_add_u32 v3, v2, 2, s89
    s_xor_b32 s89, s60, 1
    s_lshl_b32 s89, s89, 8
    s_add_u32 s89, s89, 119808
    v_lshl_add_u32 v4, v2, 2, s89
    v_mov_b32 v7, 0
    s_waitcnt vmcnt(4)
    ds_write_b128 v56, v[16:19] offset:13920
    v_alignbit_b32 v22, v17, v16, 16
    v_alignbit_b32 v23, v18, v17, 16
    v_alignbit_b32 v24, v19, v18, 16
    v_alignbit_b32 v25, v20, v19, 16
    ds_write_b128 v56, v[22:25] offset:9280
    v_alignbit_b32 v26, v18, v17, 16
    v_alignbit_b32 v27, v19, v18, 16
    v_alignbit_b32 v28, v20, v19, 16
    v_alignbit_b32 v29, v21, v20, 16
    ds_write_b128 v56, v[26:29] offset:0
    v_mov_b32 v64, v17
    v_mov_b32 v65, v18
    v_mov_b32 v66, v19
    v_mov_b32 v67, v20
    ds_write_b128 v56, v[64:67] offset:4640
    s_waitcnt vmcnt(2)
    ds_write_b128 v56, v[32:35] offset:14944
    v_alignbit_b32 v38, v33, v32, 16
    v_alignbit_b32 v39, v34, v33, 16
    v_alignbit_b32 v40, v35, v34, 16
    v_alignbit_b32 v41, v36, v35, 16
    ds_write_b128 v56, v[38:41] offset:10304
    v_alignbit_b32 v42, v34, v33, 16
    v_alignbit_b32 v43, v35, v34, 16
    v_alignbit_b32 v44, v36, v35, 16
    v_alignbit_b32 v45, v37, v36, 16
    ds_write_b128 v56, v[42:45] offset:1024
    v_mov_b32 v68, v33
    v_mov_b32 v69, v34
    v_mov_b32 v70, v35
    v_mov_b32 v71, v36
    ds_write_b128 v56, v[68:71] offset:5664
    s_waitcnt vmcnt(1)
    ds_write_b128 v57, v[48:51] offset:256
    ds_write_b64 v57, v[50:51] offset:272
    ds_write_b64 v57, v[48:49] offset:248
    s_waitcnt vmcnt(0)
    ds_write_b128 v57, v[52:55] offset:2304
    ds_write_b64 v57, v[54:55] offset:2320
    ds_write_b64 v57, v[52:53] offset:2296
    ds_write_b32 v3, v7 offset:1024
sp_1:
    ds_read_b32 v1, v4 offset:1024
    s_add_u32 s94, s94, 1
    s_cmp_gt_u32 s94, 0x100000
    s_cbranch_scc1 spd_2
    s_waitcnt lgkmcnt(0)
    v_cmp_ne_u32 vcc, 0, v1
    s_cbranch_vccnz sp_1
spd_2:
    ds_read_b128 v[64:67], v225 offset:0
    ds_read_b128 v[96:99], v224 offset:3584
    ds_read_b128 v[68:71], v225 offset:1024
    ds_read_b128 v[100:103], v224 offset:3072
    ds_read_b128 v[72:75], v225 offset:2048
    ds_read_b128 v[104:107], v224 offset:2560
    ds_read_b128 v[76:79], v225 offset:3072
    ds_read_b128 v[108:111], v224 offset:2048
    ds_read_b128 v[80:83], v225 offset:4096
    ds_read_b128 v[112:115], v224 offset:1536
    ds_read_b128 v[84:87], v225 offset:5120
    ds_read_b128 v[116:119], v224 offset:1024
    s_lshl_b32 s90, s61, 4
    s_lshr_b32 s67, s67, s90
    s_lshl_b32 s67, s67, 16
    s_waitcnt lgkmcnt(10)
    v_mfma_f32_16x16x32_bf16 v[192:195], v[96:99], v[64:67], 0
    ds_read_b128 v[88:91], v225 offset:6144
    s_waitcnt lgkmcnt(9)
    v_mfma_f32_16x16x32_bf16 v[196:199], v[100:103], v[64:67], 0
    ds_read_b128 v[120:123], v224 offset:512
    v_mfma_f32_16x16x32_bf16 v[196:199], v[96:99], v[68:71], v[196:199]
    ds_read_b128 v[92:95], v225 offset:7168
    v_mfma_f32_16x16x32_bf16 v[200:203], v[100:103], v[68:71], 0
    ds_read_b128 v[124:127], v224 offset:0
    s_waitcnt lgkmcnt(10)
    v_mfma_f32_16x16x32_bf16 v[200:203], v[104:107], v[64:67], v[200:203]
    ds_read_b128 v[128:131], v225 offset:128
    v_mfma_f32_16x16x32_bf16 v[204:207], v[104:107], v[68:71], 0
    v_mfma_f32_16x16x32_bf16 v[200:203], v[96:99], v[72:75], v[200:203]
    ds_read_b128 v[160:163], v224 offset:3648
    v_mfma_f32_16x16x32_bf16 v[204:207], v[100:103], v[72:75], v[204:207]
    v_mfma_f32_16x16x32_bf16 v[208:211], v[104:107], v[72:75], 0
    ds_read_b128 v[132:135], v225 offset:1152
    s_waitcnt lgkmcnt(11)
    v_mfma_f32_16x16x32_bf16 v[204:207], v[108:111], v[64:67], v[204:207]
    v_mfma_f32_16x16x32_bf16 v[208:211], v[108:111], v[68:71], v[208:211]
    ds_read_b128 v[164:167], v224 offset:3136
    v_mfma_f32_16x16x32_bf16 v[212:215], v[108:111], v[72:75], 0
    v_mfma_f32_16x16x32_bf16 v[204:207], v[96:99], v[76:79], v[204:207]
    ds_read_b128 v[136:139], v225 offset:2176
    v_mfma_f32_16x16x32_bf16 v[208:211], v[100:103], v[76:79], v[208:211]
    v_mfma_f32_16x16x32_bf16 v[212:215], v[104:107], v[76:79], v[212:215]
    ds_read_b128 v[168:171], v224 offset:2624
    v_mfma_f32_16x16x32_bf16 v[216:219], v[108:111], v[76:79], 0
    s_waitcnt lgkmcnt(12)
    v_mfma_f32_16x16x32_bf16 v[208:211], v[112:115], v[64:67], v[208:211]
    ds_read_b128 v[140:143], v225 offset:3200
    v_mfma_f32_16x16x32_bf16 v[212:215], v[112:115], v[68:71], v[212:215]
    v_mfma_f32_16x16x32_bf16 v[216:219], v[112:115], v[72:75], v[216:219]
    ds_read_b128 v[172:175], v224 offset:2112
    v_mfma_f32_16x16x32_bf16 v[220:223], v[112:115], v[76:79], 0
    v_mfma_f32_16x16x32_bf16 v[208:211], v[96:99], v[80:83], v[208:211]
    ds_read_b128 v[144:147], v225 offset:4224
    v_mfma_f32_16x16x32_bf16 v[212:215], v[100:103], v[80:83], v[212:215]
    v_mfma_f32_16x16x32_bf16 v[216:219], v[104:107], v[80:83], v[216:219]
    ds_read_b128 v[176:179], v224 offset:1600
    v_mfma_f32_16x16x32_bf16 v[220:223], v[108:111], v[80:83], v[220:223]
    s_waitcnt lgkmcnt(14)
    v_mfma_f32_16x16x32_bf16 v[212:215], v[116:119], v[64:67], v[212:215]
    ds_read_b128 v[148:151], v225 offset:5248
    v_mfma_f32_16x16x32_bf16 v[216:219], v[116:119], v[68:71], v[216:219]
    v_mfma_f32_16x16x32_bf16 v[220:223], v[116:119], v[72:75], v[220:223]
    ds_read_b128 v[180:183], v224 offset:1088
    v_mfma_f32_16x16x32_bf16 v[212:215], v[96:99], v[84:87], v[212:215]
    v_mfma_f32_16x16x32_bf16 v[216:219], v[100:103], v[84:87], v[216:219]
    ds_read_b128 v[152:155], v225 offset:6272
    v_mfma_f32_16x16x32_bf16 v[220:223], v[104:107], v[84:87], v[220:223]
    s_waitcnt lgkmcnt(15)
    v_mfma_f32_16x16x32_bf16 v[216:219], v[120:123], v[64:67], v[216:219]
    ds_read_b128 v[184:187], v224 offset:576
    v_mfma_f32_16x16x32_bf16 v[220:223], v[120:123], v[68:71], v[220:223]
    v_mfma_f32_16x16x32_bf16 v[216:219], v[96:99], v[88:91], v[216:219]
    ds_read_b128 v[156:159], v225 offset:7296
    v_mfma_f32_16x16x32_bf16 v[220:223], v[100:103], v[88:91], v[220:223]
    s_waitcnt lgkmcnt(15)
    v_mfma_f32_16x16x32_bf16 v[220:223], v[124:127], v[64:67], v[220:223]
    ds_read_b128 v[188:191], v224 offset:64
    v_mfma_f32_16x16x32_bf16 v[220:223], v[96:99], v[92:95], v[220:223]
    s_waitcnt lgkmcnt(14)
    v_mfma_f32_16x16x32_bf16 v[192:195], v[160:163], v[128:131], v[192:195]
    ds_read_b128 v[64:67], v225 offset:256
    s_waitcnt lgkmcnt(13)
    v_mfma_f32_16x16x32_bf16 v[196:199], v[164:167], v[128:131], v[196:199]
    v_mfma_f32_16x16x32_bf16 v[196:199], v[160:163], v[132:135], v[196:199]
    ds_read_b128 v[96:99], v224 offset:3712
    v_mfma_f32_16x16x32_bf16 v[200:203], v[164:167], v[132:135], v[200:203]
    s_waitcnt lgkmcnt(12)
    v_mfma_f32_16x16x32_bf16 v[200:203], v[168:171], v[128:131], v[200:203]
    ds_read_b128 v[68:71], v225 offset:1280
    v_mfma_f32_16x16x32_bf16 v[204:207], v[168:171], v[132:135], v[204:207]
    v_mfma_f32_16x16x32_bf16 v[200:203], v[160:163], v[136:139], v[200:203]
    ds_read_b128 v[100:103], v224 offset:3200
    v_mfma_f32_16x16x32_bf16 v[204:207], v[164:167], v[136:139], v[204:207]
    v_mfma_f32_16x16x32_bf16 v[208:211], v[168:171], v[136:139], v[208:211]
    ds_read_b128 v[72:75], v225 offset:2304
    s_waitcnt lgkmcnt(13)
    v_mfma_f32_16x16x32_bf16 v[204:207], v[172:175], v[128:131], v[204:207]
    v_mfma_f32_16x16x32_bf16 v[208:211], v[172:175], v[132:135], v[208:211]
    ds_read_b128 v[104:107], v224 offset:2688
    v_mfma_f32_16x16x32_bf16 v[212:215], v[172:175], v[136:139], v[212:215]
    v_mfma_f32_16x16x32_bf16 v[204:207], v[160:163], v[140:143], v[204:207]
    ds_read_b128 v[76:79], v225 offset:3328
    v_mfma_f32_16x16x32_bf16 v[208:211], v[164:167], v[140:143], v[208:211]
    v_mfma_f32_16x16x32_bf16 v[212:215], v[168:171], v[140:143], v[212:215]
    ds_read_b128 v[108:111], v224 offset:2176
    v_mfma_f32_16x16x32_bf16 v[216:219], v[172:175], v[140:143], v[216:219]
    s_waitcnt lgkmcnt(14)
    v_mfma_f32_16x16x32_bf16 v[208:211], v[176:179], v[128:131], v[208:211]
    ds_read_b128 v[80:83], v225 offset:4352
    v_mfma_f32_16x16x32_bf16 v[212:215], v[176:179], v[132:135], v[212:215]
    v_mfma_f32_16x16x32_bf16 v[216:219], v[176:179], v[136:139], v[216:219]
    ds_read_b128 v[112:115], v224 offset:1664
    v_mfma_f32_16x16x32_bf16 v[220:223], v[176:179], v[140:143], v[220:223]
    v_mfma_f32_16x16x32_bf16 v[208:211], v[160:163], v[144:147], v[208:211]
    ds_read_b128 v[84:87], v225 offset:5376
    v_mfma_f32_16x16x32_bf16 v[212:215], v[164:167], v[144:147], v[212:215]
    v_mfma_f32_16x16x32_bf16 v[216:219], v[168:171], v[144:147], v[216:219]
    ds_read_b128 v[116:119], v224 offset:1152
    v_mfma_f32_16x16x32_bf16 v[220:223], v[172:175], v[144:147], v[220:223]
    s_waitcnt lgkmcnt(15)
    v_mfma_f32_16x16x32_bf16 v[212:215], v[180:183], v[128:131], v[212:215]
    ds_read_b128 v[88:91], v225 offset:6400
    v_mfma_f32_16x16x32_bf16 v[216:219], v[180:183], v[132:135], v[216:219]
    v_mfma_f32_16x16x32_bf16 v[220:223], v[180:183], v[136:139], v[220:223]
    ds_read_b128 v[120:123], v224 offset:640
    v_mfma_f32_16x16x32_bf16 v[212:215], v[160:163], v[148:151], v[212:215]
    v_mfma_f32_16x16x32_bf16 v[216:219], v[164:167], v[148:151], v[216:219]
    ds_read_b128 v[92:95], v225 offset:7424
    v_mfma_f32_16x16x32_bf16 v[220:223], v[168:171], v[148:151], v[220:223]
    s_waitcnt lgkmcnt(15)
    v_mfma_f32_16x16x32_bf16 v[216:219], v[184:187], v[128:131], v[216:219]
    ds_read_b128 v[124:127], v224 offset:128
    v_mfma_f32_16x16x32_bf16 v[220:223], v[184:187], v[132:135], v[220:223]
    v_mfma_f32_16x16x32_bf16 v[216:219], v[160:163], v[152:155], v[216:219]
    v_mfma_f32_16x16x32_bf16 v[220:223], v[164:167], v[152:155], v[220:223]
    v_mfma_f32_16x16x32_bf16 v[220:223], v[188:191], v[128:131], v[220:223]
    v_mfma_f32_16x16x32_bf16 v[220:223], v[160:163], v[156:159], v[220:223]
    s_waitcnt lgkmcnt(14)
    v_mfma_f32_16x16x32_bf16 v[192:195], v[96:99], v[64:67], v[192:195]
    ds_read_b128 v[128:131], v225 offset:384
    s_waitcnt lgkmcnt(13)
    v_mfma_f32_16x16x32_bf16 v[196:199], v[100:103], v[64:67], v[196:199]
    v_mfma_f32_16x16x32_bf16 v[196:199], v[96:99], v[68:71], v[196:199]
    ds_read_b128 v[160:163], v224 offset:3776
    v_mfma_f32_16x16x32_bf16 v[200:203], v[100:103], v[68:71], v[200:203]
    s_waitcnt lgkmcnt(12)
    v_mfma_f32_16x16x32_bf16 v[200:203], v[104:107], v[64:67], v[200:203]
    ds_read_b128 v[132:135], v225 offset:1408
    v_mfma_f32_16x16x32_bf16 v[204:207], v[104:107], v[68:71], v[204:207]
    v_mfma_f32_16x16x32_bf16 v[200:203], v[96:99], v[72:75], v[200:203]
    ds_read_b128 v[164:167], v224 offset:3264
    v_mfma_f32_16x16x32_bf16 v[204:207], v[100:103], v[72:75], v[204:207]
    v_mfma_f32_16x16x32_bf16 v[208:211], v[104:107], v[72:75], v[208:211]
    ds_read_b128 v[136:139], v225 offset:2432
    s_waitcnt lgkmcnt(13)
    v_mfma_f32_16x16x32_bf16 v[204:207], v[108:111], v[64:67], v[204:207]
    v_mfma_f32_16x16x32_bf16 v[208:211], v[108:111], v[68:71], v[208:211]
    ds_read_b128 v[168:171], v224 offset:2752
    v_mfma_f32_16x16x32_bf16 v[212:215], v[108:111], v[72:75], v[212:215]
    v_mfma_f32_16x16x32_bf16 v[204:207], v[96:99], v[76:79], v[204:207]
    ds_read_b128 v[140:143], v225 offset:3456
    v_mfma_f32_16x16x32_bf16 v[208:211], v[100:103], v[76:79], v[208:211]
    v_mfma_f32_16x16x32_bf16 v[212:215], v[104:107], v[76:79], v[212:215]
    ds_read_b128 v[172:175], v224 offset:2240
    v_mfma_f32_16x16x32_bf16 v[216:219], v[108:111], v[76:79], v[216:219]
    ds_read_b32 v1, v15
    s_waitcnt lgkmcnt(15)
    v_mfma_f32_16x16x32_bf16 v[208:211], v[112:115], v[64:67], v[208:211]
    ds_read_b128 v[144:147], v225 offset:4480
    v_mfma_f32_16x16x32_bf16 v[212:215], v[112:115], v[68:71], v[212:215]
    v_mfma_f32_16x16x32_bf16 v[216:219], v[112:115], v[72:75], v[216:219]
    ds_read_b128 v[176:179], v224 offset:1728
    v_mfma_f32_16x16x32_bf16 v[220:223], v[112:115], v[76:79], v[220:223]
    s_waitcnt lgkmcnt(2)
    v_cmp_ne_u32 vcc, 0, v1
    s_cbranch_vccnz cv_fbspin
cv_fbgo:
    v_mfma_f32_16x16x32_bf16 v[208:211], v[96:99], v[80:83], v[208:211]
    ds_read_b128 v[148:151], v225 offset:5504
    ds_read_b64 v[56:57], v10 offset:3072
    v_mfma_f32_16x16x32_bf16 v[212:215], v[100:103], v[80:83], v[212:215]
    ds_read_b64 v[16:17], v13 offset:0
    v_mfma_f32_16x16x32_bf16 v[216:219], v[104:107], v[80:83], v[216:219]
    ds_read_b128 v[180:183], v224 offset:1216
    ds_read_b128 v[24:27], v60 offset:0
    v_mfma_f32_16x16x32_bf16 v[220:223], v[108:111], v[80:83], v[220:223]
    ds_read_b128 v[40:43], v60 offset:8192
    v_mfma_f32_16x16x32_bf16 v[212:215], v[116:119], v[64:67], v[212:215]
    ds_read_b128 v[152:155], v225 offset:6528
    ds_read_b64 v[58:59], v11 offset:2048
    v_mfma_f32_16x16x32_bf16 v[216:219], v[116:119], v[68:71], v[216:219]
    ds_read_b64 v[18:19], v14 offset:2048
    v_mfma_f32_16x16x32_bf16 v[220:223], v[116:119], v[72:75], v[220:223]
    ds_read_b128 v[184:187], v224 offset:704
    ds_read_b128 v[28:31], v61 offset:2048
    v_mfma_f32_16x16x32_bf16 v[212:215], v[96:99], v[84:87], v[212:215]
    ds_read_b128 v[44:47], v61 offset:10240
    v_mfma_f32_16x16x32_bf16 v[216:219], v[100:103], v[84:87], v[216:219]
    ds_read_b128 v[156:159], v225 offset:7552
    ds_read_b64 v[226:227], v10 offset:1024
    v_mfma_f32_16x16x32_bf16 v[220:223], v[104:107], v[84:87], v[220:223]
    ds_read_b64 v[20:21], v13 offset:4096
    v_mfma_f32_16x16x32_bf16 v[216:219], v[120:123], v[64:67], v[216:219]
    ds_read_b128 v[188:191], v224 offset:192
    ds_read_b128 v[32:35], v60 offset:4096
    v_mfma_f32_16x16x32_bf16 v[220:223], v[120:123], v[68:71], v[220:223]
    ds_read_b128 v[48:51], v60 offset:12288
    v_mfma_f32_16x16x32_bf16 v[216:219], v[96:99], v[88:91], v[216:219]
    ds_read_b64 v[228:229], v11 offset:0
    v_mfma_f32_16x16x32_bf16 v[220:223], v[100:103], v[88:91], v[220:223]
    ds_read_b64 v[22:23], v14 offset:6144
    v_mfma_f32_16x16x32_bf16 v[220:223], v[124:127], v[64:67], v[220:223]
    ds_read_b128 v[36:39], v61 offset:6144
    v_mfma_f32_16x16x32_bf16 v[220:223], v[96:99], v[92:95], v[220:223]
    ds_read_b128 v[52:55], v61 offset:14336
    s_cmp_eq_u32 s62, 0
    s_waitcnt lgkmcnt(0)
    s_cbranch_scc0 conv_h1
    v_mfma_f32_16x16x32_bf16 v[196:199], v[164:167], v[128:131], v[196:199]
    v_lshlrev_b32 v232, 16, v16
    v_and_b32 v233, s92, v16
    v_lshlrev_b32 v234, 16, v17
    v_mfma_f32_16x16x32_bf16 v[196:199], v[160:163], v[132:135], v[196:199]
    v_and_b32 v235, s92, v17
    v_lshlrev_b32 v236, 16, v18
    v_and_b32 v237, s92, v18
    v_mfma_f32_16x16x32_bf16 v[200:203], v[164:167], v[132:135], v[200:203]
    v_lshlrev_b32 v238, 16, v19
    v_and_b32 v239, s92, v19
    v_lshlrev_b32 v240, 16, v20
    v_mfma_f32_16x16x32_bf16 v[200:203], v[168:171], v[128:131], v[200:203]
    v_and_b32 v241, s92, v20
    v_lshlrev_b32 v242, 16, v21
    v_and_b32 v243, s92, v21
    v_mfma_f32_16x16x32_bf16 v[200:203], v[160:163], v[136:139], v[200:203]
    v_lshlrev_b32 v244, 16, v22
    v_and_b32 v245, s92, v22
    v_lshlrev_b32 v246, 16, v23
    ds_write_b128 v62, v[196:199] offset:0
    v_mfma_f32_16x16x32_bf16 v[212:215], v[172:175], v[136:139], v[212:215]
    v_and_b32 v247, s92, v23
    v_fma_f32 v24, v232, v24, v40
    v_fma_f32 v25, v233, v25, v41
    v_mfma_f32_16x16x32_bf16 v[212:215], v[168:171], v[140:143], v[212:215]
    v_fma_f32 v26, v234, v26, v42
    v_fma_f32 v27, v235, v27, v43
    v_fma_f32 v28, v236, v28, v44
    v_mfma_f32_16x16x32_bf16 v[212:215], v[176:179], v[132:135], v[212:215]
    v_fma_f32 v29, v237, v29, v45
    v_fma_f32 v30, v238, v30, v46
    v_fma_f32 v31, v239, v31, v47
    ds_write_b128 v62, v[200:203] offset:1024
    v_mfma_f32_16x16x32_bf16 v[212:215], v[164:167], v[144:147], v[212:215]
    v_fma_f32 v32, v240, v32, v48
    v_fma_f32 v33, v241, v33, v49
    v_fma_f32 v34, v242, v34, v50
    v_mfma_f32_16x16x32_bf16 v[212:215], v[180:183], v[128:131], v[212:215]
    v_fma_f32 v35, v243, v35, v51
    v_fma_f32 v36, v244, v36, v52
    v_fma_f32 v37, v245, v37, v53
    v_mfma_f32_16x16x32_bf16 v[212:215], v[160:163], v[148:151], v[212:215]
    v_fma_f32 v38, v246, v38, v54
    v_fma_f32 v39, v247, v39, v55
    v_and_b32 v40, s92, v57
    v_mfma_f32_16x16x32_bf16 v[216:219], v[172:175], v[140:143], v[216:219]
    v_lshlrev_b32 v41, 16, v57
    v_and_b32 v42, s92, v56
    v_lshlrev_b32 v43, 16, v56
    v_mfma_f32_16x16x32_bf16 v[216:219], v[176:179], v[136:139], v[216:219]
    v_and_b32 v44, s92, v59
    v_lshlrev_b32 v45, 16, v59
    v_and_b32 v46, s92, v58
    v_mfma_f32_16x16x32_bf16 v[216:219], v[168:171], v[144:147], v[216:219]
    v_lshlrev_b32 v47, 16, v58
    v_and_b32 v48, s92, v227
    v_lshlrev_b32 v49, 16, v227
    ds_write_b128 v62, v[212:215] offset:2048
    v_mfma_f32_16x16x32_bf16 v[216:219], v[180:183], v[132:135], v[216:219]
    v_and_b32 v50, s92, v226
    v_lshlrev_b32 v51, 16, v226
    v_and_b32 v52, s92, v229
    v_mfma_f32_16x16x32_bf16 v[216:219], v[164:167], v[148:151], v[216:219]
    v_lshlrev_b32 v53, 16, v229
    v_and_b32 v54, s92, v228
    v_lshlrev_b32 v55, 16, v228
    v_mfma_f32_16x16x32_bf16 v[216:219], v[184:187], v[128:131], v[216:219]
    v_mul_f32 v40, v40, v24
    v_mul_f32 v41, v41, v25
    v_mul_f32 v42, v42, v26
    v_mfma_f32_16x16x32_bf16 v[216:219], v[160:163], v[152:155], v[216:219]
    v_mul_f32 v43, v43, v27
    v_mul_f32 v44, v44, v28
    v_mul_f32 v45, v45, v29
    v_mfma_f32_16x16x32_bf16 v[192:195], v[160:163], v[128:131], v[192:195]
    v_mul_f32 v46, v46, v30
    v_mul_f32 v47, v47, v31
    v_mfma_f32_16x16x32_bf16 v[204:207], v[168:171], v[132:135], v[204:207]
    v_mul_f32 v48, v48, v32
    v_mul_f32 v49, v49, v33
    v_mfma_f32_16x16x32_bf16 v[204:207], v[164:167], v[136:139], v[204:207]
    v_mul_f32 v50, v50, v34
    v_mul_f32 v51, v51, v35
    ds_write_b128 v62, v[216:219] offset:3072
    v_mfma_f32_16x16x32_bf16 v[204:207], v[172:175], v[128:131], v[204:207]
    v_mul_f32 v52, v52, v36
    v_mul_f32 v53, v53, v37
    ds_write_b32 v3, v7
    v_mfma_f32_16x16x32_bf16 v[204:207], v[160:163], v[140:143], v[204:207]
    v_mul_f32 v54, v54, v38
    v_mul_f32 v55, v55, v39
    v_mfma_f32_16x16x32_bf16 v[208:211], v[168:171], v[136:139], v[208:211]
    v_fmac_f32 v232, s67, v40
    v_fmac_f32 v233, s67, v41
    v_mfma_f32_16x16x32_bf16 v[208:211], v[172:175], v[132:135], v[208:211]
    v_fmac_f32 v234, s67, v42
    v_fmac_f32 v235, s67, v43
    v_mfma_f32_16x16x32_bf16 v[208:211], v[164:167], v[140:143], v[208:211]
    v_fmac_f32 v236, s67, v44
    v_fmac_f32 v237, s67, v45
    ds_read_b32 v1, v4
    v_mfma_f32_16x16x32_bf16 v[208:211], v[176:179], v[128:131], v[208:211]
    v_fmac_f32 v238, s67, v46
    v_fmac_f32 v239, s67, v47
    v_mfma_f32_16x16x32_bf16 v[208:211], v[160:163], v[144:147], v[208:211]
    v_fmac_f32 v240, s67, v48
    v_fmac_f32 v241, s67, v49
    v_mfma_f32_16x16x32_bf16 v[220:223], v[176:179], v[140:143], v[220:223]
    v_fmac_f32 v242, s67, v50
    v_fmac_f32 v243, s67, v51
    v_mfma_f32_16x16x32_bf16 v[220:223], v[172:175], v[144:147], v[220:223]
    v_fmac_f32 v244, s67, v52
    v_fmac_f32 v245, s67, v53
    v_mfma_f32_16x16x32_bf16 v[220:223], v[180:183], v[136:139], v[220:223]
    v_fmac_f32 v246, s67, v54
    v_fmac_f32 v247, s67, v55
    s_waitcnt lgkmcnt(0)
    v_cmp_ne_u32 vcc, 0, v1
    s_cbranch_vccnz cv_rspin0
cv_rgo0:
    ds_read_b128 v[64:67], v63 offset:0
    ds_read_b128 v[68:71], v63 offset:1024
    v_mfma_f32_16x16x32_bf16 v[220:223], v[168:171], v[148:151], v[220:223]
    ds_read_b128 v[72:75], v63 offset:2048
    ds_read_b128 v[76:79], v63 offset:3072
    v_mfma_f32_16x16x32_bf16 v[220:223], v[184:187], v[132:135], v[220:223]
    v_fmac_f32 v232, v24, v192
    v_fmac_f32 v233, v25, v193
    v_fmac_f32 v234, v26, v194
    v_fmac_f32 v235, v27, v195
    v_mfma_f32_16x16x32_bf16 v[220:223], v[164:167], v[152:155], v[220:223]
    v_fmac_f32 v236, v28, v204
    v_fmac_f32 v237, v29, v205
    v_fmac_f32 v238, v30, v206
    v_fmac_f32 v239, v31, v207
    v_mfma_f32_16x16x32_bf16 v[220:223], v[188:191], v[128:131], v[220:223]
    v_fmac_f32 v240, v32, v208
    v_fmac_f32 v241, v33, v209
    v_fmac_f32 v242, v34, v210
    v_fmac_f32 v243, v35, v211
    v_mfma_f32_16x16x32_bf16 v[220:223], v[160:163], v[156:159], v[220:223]
    s_waitcnt lgkmcnt(3)
    v_fmac_f32 v232, v24, v64
    v_fmac_f32 v233, v25, v65
    v_fmac_f32 v234, v26, v66
    v_fmac_f32 v235, v27, v67
    v_cvt_pk_bf16_f32 v88, v232, v233
    v_cvt_pk_bf16_f32 v89, v234, v235
    buffer_store_dwordx2 v[88:89], v12, s[32:35], s50 offen
    s_waitcnt lgkmcnt(2)
    v_fmac_f32 v236, v28, v68
    v_fmac_f32 v237, v29, v69
    v_fmac_f32 v238, v30, v70
    v_fmac_f32 v239, v31, v71
    v_cvt_pk_bf16_f32 v90, v236, v237
    v_cvt_pk_bf16_f32 v91, v238, v239
    buffer_store_dwordx2 v[90:91], v12, s[32:35], s51 offen
    s_waitcnt lgkmcnt(1)
    v_fmac_f32 v240, v32, v72
    v_fmac_f32 v241, v33, v73
    v_fmac_f32 v242, v34, v74
    v_fmac_f32 v243, v35, v75
    v_cvt_pk_bf16_f32 v92, v240, v241
    v_cvt_pk_bf16_f32 v93, v242, v243
    buffer_store_dwordx2 v[92:93], v12, s[32:35], s52 offen
    s_waitcnt lgkmcnt(0)
    v_fmac_f32 v244, v36, v76
    v_fmac_f32 v245, v37, v77
    v_fmac_f32 v246, v38, v78
    v_fmac_f32 v247, v39, v79
    v_fmac_f32 v244, v36, v220
    v_fmac_f32 v245, v37, v221
    v_fmac_f32 v246, v38, v222
    v_fmac_f32 v247, v39, v223
    v_cvt_pk_bf16_f32 v94, v244, v245
    v_cvt_pk_bf16_f32 v95, v246, v247
    buffer_store_dwordx2 v[94:95], v12, s[32:35], s53 offen
    s_endpgm
conv_h1:
    v_mfma_f32_16x16x32_bf16 v[192:195], v[160:163], v[128:131], v[192:195]
    v_lshlrev_b32 v232, 16, v16
    v_and_b32 v233, s92, v16
    v_lshlrev_b32 v234, 16, v17
    v_mfma_f32_16x16x32_bf16 v[204:207], v[168:171], v[132:135], v[204:207]
    v_and_b32 v235, s92, v17
    v_lshlrev_b32 v236, 16, v18
    v_and_b32 v237, s92, v18
    v_mfma_f32_16x16x32_bf16 v[204:207], v[164:167], v[136:139], v[204:207]
    v_lshlrev_b32 v238, 16, v19
    v_and_b32 v239, s92, v19
    v_lshlrev_b32 v240, 16, v20
    v_mfma_f32_16x16x32_bf16 v[204:207], v[172:175], v[128:131], v[204:207]
    v_and_b32 v241, s92, v20
    v_lshlrev_b32 v242, 16, v21
    v_and_b32 v243, s92, v21
    ds_write_b128 v62, v[192:195] offset:0
    v_mfma_f32_16x16x32_bf16 v[204:207], v[160:163], v[140:143], v[204:207]
    v_lshlrev_b32 v244, 16, v22
    v_and_b32 v245, s92, v22
    v_lshlrev_b32 v246, 16, v23
    v_mfma_f32_16x16x32_bf16 v[208:211], v[168:171], v[136:139], v[208:211]
    v_and_b32 v247, s92, v23
    v_fma_f32 v24, v232, v24, v40
    v_fma_f32 v25, v233, v25, v41
    v_mfma_f32_16x16x32_bf16 v[208:211], v[172:175], v[132:135], v[208:211]
    v_fma_f32 v26, v234, v26, v42
    v_fma_f32 v27, v235, v27, v43
    v_fma_f32 v28, v236, v28, v44
    v_mfma_f32_16x16x32_bf16 v[208:211], v[164:167], v[140:143], v[208:211]
    v_fma_f32 v29, v237, v29, v45
    v_fma_f32 v30, v238, v30, v46
    v_fma_f32 v31, v239, v31, v47
    ds_write_b128 v62, v[204:207] offset:1024
    v_mfma_f32_16x16x32_bf16 v[208:211], v[176:179], v[128:131], v[208:211]
    v_fma_f32 v32, v240, v32, v48
    v_fma_f32 v33, v241, v33, v49
    v_fma_f32 v34, v242, v34, v50
    v_mfma_f32_16x16x32_bf16 v[208:211], v[160:163], v[144:147], v[208:211]
    v_fma_f32 v35, v243, v35, v51
    v_fma_f32 v36, v244, v36, v52
    v_fma_f32 v37, v245, v37, v53
    v_mfma_f32_16x16x32_bf16 v[220:223], v[176:179], v[140:143], v[220:223]
    v_fma_f32 v38, v246, v38, v54
    v_fma_f32 v39, v247, v39, v55
    v_and_b32 v40, s92, v57
    v_mfma_f32_16x16x32_bf16 v[220:223], v[172:175], v[144:147], v[220:223]
    v_lshlrev_b32 v41, 16, v57
    v_and_b32 v42, s92, v56
    v_lshlrev_b32 v43, 16, v56
    v_mfma_f32_16x16x32_bf16 v[220:223], v[180:183], v[136:139], v[220:223]
    v_and_b32 v44, s92, v59
    v_lshlrev_b32 v45, 16, v59
    v_and_b32 v46, s92, v58
    ds_write_b128 v62, v[208:211] offset:2048
    v_mfma_f32_16x16x32_bf16 v[220:223], v[168:171], v[148:151], v[220:223]
    v_lshlrev_b32 v47, 16, v58
    v_and_b32 v48, s92, v227
    v_lshlrev_b32 v49, 16, v227
    v_mfma_f32_16x16x32_bf16 v[220:223], v[184:187], v[132:135], v[220:223]
    v_and_b32 v50, s92, v226
    v_lshlrev_b32 v51, 16, v226
    v_and_b32 v52, s92, v229
    v_mfma_f32_16x16x32_bf16 v[220:223], v[164:167], v[152:155], v[220:223]
    v_lshlrev_b32 v53, 16, v229
    v_and_b32 v54, s92, v228
    v_lshlrev_b32 v55, 16, v228
    v_mfma_f32_16x16x32_bf16 v[220:223], v[188:191], v[128:131], v[220:223]
    v_mul_f32 v40, v40, v24
    v_mul_f32 v41, v41, v25
    v_mul_f32 v42, v42, v26
    v_mfma_f32_16x16x32_bf16 v[220:223], v[160:163], v[156:159], v[220:223]
    v_mul_f32 v43, v43, v27
    v_mul_f32 v44, v44, v28
    v_mul_f32 v45, v45, v29
    v_mfma_f32_16x16x32_bf16 v[196:199], v[164:167], v[128:131], v[196:199]
    v_mul_f32 v46, v46, v30
    v_mul_f32 v47, v47, v31
    v_mfma_f32_16x16x32_bf16 v[196:199], v[160:163], v[132:135], v[196:199]
    v_mul_f32 v48, v48, v32
    v_mul_f32 v49, v49, v33
    v_mfma_f32_16x16x32_bf16 v[200:203], v[164:167], v[132:135], v[200:203]
    v_mul_f32 v50, v50, v34
    v_mul_f32 v51, v51, v35
    ds_write_b128 v62, v[220:223] offset:3072
    v_mfma_f32_16x16x32_bf16 v[200:203], v[168:171], v[128:131], v[200:203]
    v_mul_f32 v52, v52, v36
    v_mul_f32 v53, v53, v37
    ds_write_b32 v3, v7
    v_mfma_f32_16x16x32_bf16 v[200:203], v[160:163], v[136:139], v[200:203]
    v_mul_f32 v54, v54, v38
    v_mul_f32 v55, v55, v39
    v_mfma_f32_16x16x32_bf16 v[212:215], v[172:175], v[136:139], v[212:215]
    v_fmac_f32 v232, s67, v40
    v_fmac_f32 v233, s67, v41
    v_mfma_f32_16x16x32_bf16 v[212:215], v[168:171], v[140:143], v[212:215]
    v_fmac_f32 v234, s67, v42
    v_fmac_f32 v235, s67, v43
    v_mfma_f32_16x16x32_bf16 v[212:215], v[176:179], v[132:135], v[212:215]
    v_fmac_f32 v236, s67, v44
    v_fmac_f32 v237, s67, v45
    ds_read_b32 v1, v4
    v_mfma_f32_16x16x32_bf16 v[212:215], v[164:167], v[144:147], v[212:215]
    v_fmac_f32 v238, s67, v46
    v_fmac_f32 v239, s67, v47
    v_mfma_f32_16x16x32_bf16 v[212:215], v[180:183], v[128:131], v[212:215]
    v_fmac_f32 v240, s67, v48
    v_fmac_f32 v241, s67, v49
    v_mfma_f32_16x16x32_bf16 v[212:215], v[160:163], v[148:151], v[212:215]
    v_fmac_f32 v242, s67, v50
    v_fmac_f32 v243, s67, v51
    v_mfma_f32_16x16x32_bf16 v[216:219], v[172:175], v[140:143], v[216:219]
    v_fmac_f32 v244, s67, v52
    v_fmac_f32 v245, s67, v53
    v_mfma_f32_16x16x32_bf16 v[216:219], v[176:179], v[136:139], v[216:219]
    v_fmac_f32 v246, s67, v54
    v_fmac_f32 v247, s67, v55
    s_waitcnt lgkmcnt(0)
    v_cmp_ne_u32 vcc, 0, v1
    s_cbranch_vccnz cv_rspin1
cv_rgo1:
    ds_read_b128 v[64:67], v63 offset:0
    ds_read_b128 v[68:71], v63 offset:1024
    v_mfma_f32_16x16x32_bf16 v[216:219], v[168:171], v[144:147], v[216:219]
    ds_read_b128 v[72:75], v63 offset:2048
    ds_read_b128 v[76:79], v63 offset:3072
    v_mfma_f32_16x16x32_bf16 v[216:219], v[180:183], v[132:135], v[216:219]
    v_fmac_f32 v232, v24, v196
    v_fmac_f32 v233, v25, v197
    v_fmac_f32 v234, v26, v198
    v_fmac_f32 v235, v27, v199
    v_mfma_f32_16x16x32_bf16 v[216:219], v[164:167], v[148:151], v[216:219]
    v_fmac_f32 v236, v28, v200
    v_fmac_f32 v237, v29, v201
    v_fmac_f32 v238, v30, v202
    v_fmac_f32 v239, v31, v203
    v_mfma_f32_16x16x32_bf16 v[216:219], v[184:187], v[128:131], v[216:219]
    v_fmac_f32 v240, v32, v212
    v_fmac_f32 v241, v33, v213
    v_fmac_f32 v242, v34, v214
    v_fmac_f32 v243, v35, v215
    v_mfma_f32_16x16x32_bf16 v[216:219], v[160:163], v[152:155], v[216:219]
    s_waitcnt lgkmcnt(3)
    v_fmac_f32 v232, v24, v64
    v_fmac_f32 v233, v25, v65
    v_fmac_f32 v234, v26, v66
    v_fmac_f32 v235, v27, v67
    v_cvt_pk_bf16_f32 v88, v232, v233
    v_cvt_pk_bf16_f32 v89, v234, v235
    buffer_store_dwordx2 v[88:89], v12, s[32:35], s50 offen
    s_waitcnt lgkmcnt(2)
    v_fmac_f32 v236, v28, v68
    v_fmac_f32 v237, v29, v69
    v_fmac_f32 v238, v30, v70
    v_fmac_f32 v239, v31, v71
    v_cvt_pk_bf16_f32 v90, v236, v237
    v_cvt_pk_bf16_f32 v91, v238, v239
    buffer_store_dwordx2 v[90:91], v12, s[32:35], s51 offen
    s_waitcnt lgkmcnt(1)
    v_fmac_f32 v240, v32, v72
    v_fmac_f32 v241, v33, v73
    v_fmac_f32 v242, v34, v74
    v_fmac_f32 v243, v35, v75
    v_cvt_pk_bf16_f32 v92, v240, v241
    v_cvt_pk_bf16_f32 v93, v242, v243
    buffer_store_dwordx2 v[92:93], v12, s[32:35], s52 offen
    s_waitcnt lgkmcnt(0)
    v_fmac_f32 v244, v36, v76
    v_fmac_f32 v245, v37, v77
    v_fmac_f32 v246, v38, v78
    v_fmac_f32 v247, v39, v79
    v_fmac_f32 v244, v36, v216
    v_fmac_f32 v245, v37, v217
    v_fmac_f32 v246, v38, v218
    v_fmac_f32 v247, v39, v219
    v_cvt_pk_bf16_f32 v94, v244, v245
    v_cvt_pk_bf16_f32 v95, v246, v247
    buffer_store_dwordx2 v[94:95], v12, s[32:35], s53 offen
    s_endpgm
cv_fbspin:
sp_3:
    ds_read_b32 v1, v15 offset:0
    s_add_u32 s94, s94, 1
    s_cmp_gt_u32 s94, 0x100000
    s_cbranch_scc1 spd_4
    s_waitcnt lgkmcnt(0)
    v_cmp_ne_u32 vcc, 0, v1
    s_cbranch_vccnz sp_3
spd_4:
    s_branch cv_fbgo
cv_rspin0:
sp_5:
    ds_read_b32 v1, v4 offset:0
    s_add_u32 s94, s94, 1
    s_cmp_gt_u32 s94, 0x100000
    s_cbranch_scc1 spd_6
    s_waitcnt lgkmcnt(0)
    v_cmp_ne_u32 vcc, 0, v1
    s_cbranch_vccnz sp_5
spd_6:
    s_branch cv_rgo0
cv_rspin1:
sp_7:
    ds_read_b32 v1, v4 offset:0
    s_add_u32 s94, s94, 1
    s_cmp_gt_u32 s94, 0x100000
    s_cbranch_scc1 spd_8
    s_waitcnt lgkmcnt(0)
    v_cmp_ne_u32 vcc, 0, v1
    s_cbranch_vccnz sp_7
spd_8:
    s_branch cv_rgo1
cv_help:
    s_load_dwordx4 s[8:11], s[0:1], 56
    s_load_dwordx2 s[12:13], s[0:1], 72
    s_and_b32 s61, s60, 3
    v_mov_b32 v32, 0
    v_mov_b32 v33, 0
    v_mov_b32 v34, -1
    s_mul_i32 s62, s61, 9280
    v_add_u32 v35, s62, v5
    ds_write_b64 v35, v[32:33] offset:4096
    ds_write_b64 v35, v[32:33] offset:8736
    s_and_b32 s62, s61, 1
    s_mul_i32 s62, s62, 8448
    s_add_u32 s62, s62, 37120
    v_lshl_add_u32 v35, v2, 2, s62
    ds_write_b32 v35, v32
    s_lshl_b32 s62, s61, 8
    s_add_u32 s62, s62, 119552
    v_lshl_add_u32 v35, v2, 2, s62
    ds_write_b32 v35, v34
    ds_write_b32 v35, v34 offset:256
    ds_write_b32 v35, v34 offset:1280
    s_mul_hi_u32 s78, s2, 153391690
    s_mul_i32 s79, s78, 28
    s_sub_u32 s79, s2, s79
    s_lshl_b32 s66, s61, 13
    s_add_u32 s66, s66, 94976
    s_lshl_b32 s62, s61, 12
    s_add_u32 s63, s62, 4268032
    s_mul_i32 s64, s61, 526336
    s_lshl_b32 s65, s16, 7
    s_add_u32 s64, s64, s65
    s_add_u32 s64, s64, 2162688
    s_add_u32 s65, s64, 262144
    v_lshrrev_b32 v9, 3, v2
    v_mul_u32_u24 v9, 32896, v9
    v_and_b32 v10, 7, v2
    v_lshl_add_u32 v9, v10, 4, v9
    s_add_u32 m0, s62, 70400
    s_waitcnt lgkmcnt(0)
    s_barrier
    s_mov_b32 s20, s14
    s_mov_b32 s21, s15
    s_mov_b32 s22, 0x1286000
    s_mov_b32 s23, 0x20000
    s_barrier
    buffer_load_dwordx4 v6, s[20:23], s63 offen offset:0 lds
    buffer_load_dwordx4 v6, s[20:23], s63 offen offset:1024 lds
    buffer_load_dwordx4 v6, s[20:23], s63 offen offset:2048 lds
    buffer_load_dwordx4 v6, s[20:23], s63 offen offset:3072 lds
    s_lshl_b32 s62, s61, 11
    s_add_u32 m0, s62, 86784
    s_lshl_b32 s62, s61, 2
    buffer_load_dwordx4 v9, s[20:23], s64 offen lds
    buffer_load_dwordx4 v9, s[20:23], s65 offen offset:1024 lds
    s_add_u32 m0, s62, 119568
    s_mov_b64 exec, 1
    buffer_load_dword v6, s[20:23], s93 offen lds
    s_mov_b64 exec, -1
    v_and_b32 v3, 15, v2
    v_lshrrev_b32 v4, 4, v2
    v_lshrrev_b32 v24, 2, v3
    v_and_b32 v25, 3, v3
    v_lshrrev_b32 v26, 1, v4
    v_and_b32 v27, 1, v4
    s_mov_b32 m0, s66
    s_cmp_ge_u32 s2, 224
    s_cbranch_scc1 cv_hend
    s_cmp_eq_u32 s61, 3
    s_cbranch_scc1 cv_hend
    s_cmp_eq_u32 s61, 2
    s_cbranch_scc1 cv_wd
    s_cmp_eq_u32 s61, 0
    s_cselect_b32 s28, s8, s10
    s_cselect_b32 s29, s9, s11
    s_mov_b32 s30, 0x1c0000
    s_mov_b32 s31, 0x20000
    v_and_b32 v7, 7, v2
    v_lshrrev_b32 v13, 3, v2
    v_mul_u32_u24 v13, 3584, v13
    v_lshl_add_u32 v13, v7, 4, v13
    s_mul_i32 s80, s78, 229376
    s_lshl_b32 s81, s79, 7
    s_add_u32 s80, s80, s81
    buffer_load_dwordx4 v[64:67], v13, s[28:31], s80 offen
    s_add_u32 s80, s80, 28672
    buffer_load_dwordx4 v[68:71], v13, s[28:31], s80 offen
    s_add_u32 s80, s80, 28672
    buffer_load_dwordx4 v[72:75], v13, s[28:31], s80 offen
    s_add_u32 s80, s80, 28672
    buffer_load_dwordx4 v[76:79], v13, s[28:31], s80 offen
    s_add_u32 s80, s80, 28672
    buffer_load_dwordx4 v[80:83], v13, s[28:31], s80 offen
    s_add_u32 s80, s80, 28672
    buffer_load_dwordx4 v[84:87], v13, s[28:31], s80 offen
    s_add_u32 s80, s80, 28672
    buffer_load_dwordx4 v[88:91], v13, s[28:31], s80 offen
    s_add_u32 s80, s80, 28672
    buffer_load_dwordx4 v[92:95], v13, s[28:31], s80 offen
    v_add_u32 v12, s66, v6
    v_lshl_add_u32 v28, v26, 3, v24
    v_lshlrev_b32 v28, 7, v28
    v_lshl_add_u32 v28, v27, 5, v28
    v_lshl_add_u32 v28, v25, 3, v28
    v_add_u32 v28, s66, v28
    s_lshl_b32 s82, s79, 2
    s_add_u32 s82, s82, 0
    s_mul_hi_u32 s83, s82, 613566757
    s_mul_i32 s84, s83, 7
    s_sub_u32 s84, s82, s84
    s_mul_i32 s83, s83, 237568
    s_lshl_b32 s84, s84, 10
    s_add_u32 s40, s83, s84
    s_lshl_b32 s82, s79, 2
    s_add_u32 s82, s82, 1
    s_mul_hi_u32 s83, s82, 613566757
    s_mul_i32 s84, s83, 7
    s_sub_u32 s84, s82, s84
    s_mul_i32 s83, s83, 237568
    s_lshl_b32 s84, s84, 10
    s_add_u32 s41, s83, s84
    s_lshl_b32 s82, s79, 2
    s_add_u32 s82, s82, 2
    s_mul_hi_u32 s83, s82, 613566757
    s_mul_i32 s84, s83, 7
    s_sub_u32 s84, s82, s84
    s_mul_i32 s83, s83, 237568
    s_lshl_b32 s84, s84, 10
    s_add_u32 s42, s83, s84
    s_lshl_b32 s82, s79, 2
    s_add_u32 s82, s82, 3
    s_mul_hi_u32 s83, s82, 613566757
    s_mul_i32 s84, s83, 7
    s_sub_u32 s84, s82, s84
    s_mul_i32 s83, s83, 237568
    s_lshl_b32 s84, s84, 10
    s_add_u32 s43, s83, s84
    s_lshl_b32 s82, s61, 4
    v_lshl_add_u32 v29, v26, 5, v3
    v_add_u32 v29, s82, v29
    v_lshlrev_b32 v29, 4, v29
    v_cmp_eq_u32 vcc, 1, v27
    v_mov_b32 v30, s40
    v_mov_b32 v8, s41
    v_cndmask_b32 v30, v30, v8, vcc
    v_add_u32 v30, v30, v29
    v_mov_b32 v31, s42
    v_mov_b32 v8, s43
    v_cndmask_b32 v31, v31, v8, vcc
    v_add_u32 v31, v31, v29
    s_mul_i32 s44, s78, 28672
    s_add_u32 s44, s44, 6447104
    s_lshr_b32 s46, s78, 2
    s_lshl_b32 s46, s46, 9
    s_and_b32 s47, s78, 3
    s_lshl_b32 s47, s47, 2
    s_add_u32 s46, s46, s47
    s_add_u32 s46, s46, 6676480
    v_mov_b32 v16, 0
    v_mov_b32 v17, 0
    v_mov_b32 v18, 0
    v_mov_b32 v19, 0
    s_mov_b32 s45, 0x3f803f80
    s_waitcnt vmcnt(6)
    ds_write_b128 v12, v[64:67] offset:0
    ds_write_b128 v12, v[68:71] offset:1024
    ds_read_b64_tr_b16 v[32:33], v28 offset:0
    ds_read_b64_tr_b16 v[34:35], v28 offset:512
    ds_read_b64_tr_b16 v[36:37], v28 offset:64
    ds_read_b64_tr_b16 v[38:39], v28 offset:576
    s_waitcnt lgkmcnt(2)
    buffer_store_dwordx4 v[32:35], v30, s[20:23], s44 offen sc1
    s_waitcnt lgkmcnt(0)
    buffer_store_dwordx4 v[36:39], v31, s[20:23], s44 offen sc1
    v_dot2c_f32_bf16 v16, s45, v32
    v_dot2c_f32_bf16 v17, s45, v33
    v_dot2c_f32_bf16 v16, s45, v34
    v_dot2c_f32_bf16 v17, s45, v35
    v_dot2c_f32_bf16 v18, s45, v36
    v_dot2c_f32_bf16 v19, s45, v37
    v_dot2c_f32_bf16 v18, s45, v38
    v_dot2c_f32_bf16 v19, s45, v39
    s_add_u32 s44, s44, 7168
    s_waitcnt vmcnt(6)
    ds_write_b128 v12, v[72:75] offset:2048
    ds_write_b128 v12, v[76:79] offset:3072
    ds_read_b64_tr_b16 v[40:41], v28 offset:2048
    ds_read_b64_tr_b16 v[42:43], v28 offset:2560
    ds_read_b64_tr_b16 v[44:45], v28 offset:2112
    ds_read_b64_tr_b16 v[46:47], v28 offset:2624
    s_waitcnt lgkmcnt(2)
    buffer_store_dwordx4 v[40:43], v30, s[20:23], s44 offen sc1
    s_waitcnt lgkmcnt(0)
    buffer_store_dwordx4 v[44:47], v31, s[20:23], s44 offen sc1
    v_dot2c_f32_bf16 v16, s45, v40
    v_dot2c_f32_bf16 v17, s45, v41
    v_dot2c_f32_bf16 v16, s45, v42
    v_dot2c_f32_bf16 v17, s45, v43
    v_dot2c_f32_bf16 v18, s45, v44
    v_dot2c_f32_bf16 v19, s45, v45
    v_dot2c_f32_bf16 v18, s45, v46
    v_dot2c_f32_bf16 v19, s45, v47
    s_add_u32 s44, s44, 7168
    s_waitcnt vmcnt(6)
    ds_write_b128 v12, v[80:83] offset:4096
    ds_write_b128 v12, v[84:87] offset:5120
    ds_read_b64_tr_b16 v[48:49], v28 offset:4096
    ds_read_b64_tr_b16 v[50:51], v28 offset:4608
    ds_read_b64_tr_b16 v[52:53], v28 offset:4160
    ds_read_b64_tr_b16 v[54:55], v28 offset:4672
    s_waitcnt lgkmcnt(2)
    buffer_store_dwordx4 v[48:51], v30, s[20:23], s44 offen sc1
    s_waitcnt lgkmcnt(0)
    buffer_store_dwordx4 v[52:55], v31, s[20:23], s44 offen sc1
    v_dot2c_f32_bf16 v16, s45, v48
    v_dot2c_f32_bf16 v17, s45, v49
    v_dot2c_f32_bf16 v16, s45, v50
    v_dot2c_f32_bf16 v17, s45, v51
    v_dot2c_f32_bf16 v18, s45, v52
    v_dot2c_f32_bf16 v19, s45, v53
    v_dot2c_f32_bf16 v18, s45, v54
    v_dot2c_f32_bf16 v19, s45, v55
    s_add_u32 s44, s44, 7168
    s_waitcnt vmcnt(6)
    ds_write_b128 v12, v[88:91] offset:6144
    ds_write_b128 v12, v[92:95] offset:7168
    ds_read_b64_tr_b16 v[56:57], v28 offset:6144
    ds_read_b64_tr_b16 v[58:59], v28 offset:6656
    ds_read_b64_tr_b16 v[60:61], v28 offset:6208
    ds_read_b64_tr_b16 v[62:63], v28 offset:6720
    s_waitcnt lgkmcnt(2)
    buffer_store_dwordx4 v[56:59], v30, s[20:23], s44 offen sc1
    s_waitcnt lgkmcnt(0)
    buffer_store_dwordx4 v[60:63], v31, s[20:23], s44 offen sc1
    v_dot2c_f32_bf16 v16, s45, v56
    v_dot2c_f32_bf16 v17, s45, v57
    v_dot2c_f32_bf16 v16, s45, v58
    v_dot2c_f32_bf16 v17, s45, v59
    v_dot2c_f32_bf16 v18, s45, v60
    v_dot2c_f32_bf16 v19, s45, v61
    v_dot2c_f32_bf16 v18, s45, v62
    v_dot2c_f32_bf16 v19, s45, v63
    s_add_u32 s44, s44, 7168
    s_nop 2
    v_add_f32 v16, v16, v17
    v_mov_b32 v17, v16
    s_nop 1
    v_permlane32_swap_b32 v16, v17
    v_add_f32 v16, v16, v17
    v_cvt_pk_bf16_f32 v17, v16, v16
    v_lshlrev_b32 v17, 16, v17
    v_sub_f32 v16, v16, v17
    v_cvt_pk_bf16_f32 v16, v17, v16
    v_add_f32 v18, v18, v19
    v_mov_b32 v19, v18
    s_nop 1
    v_permlane32_swap_b32 v18, v19
    v_add_f32 v18, v18, v19
    v_cvt_pk_bf16_f32 v19, v18, v18
    v_lshlrev_b32 v19, 16, v19
    v_sub_f32 v18, v18, v19
    v_cvt_pk_bf16_f32 v18, v19, v18
    s_mov_b32 exec_hi, 0
    buffer_store_dword v16, v30, s[20:23], s46 offen
    buffer_store_dword v18, v31, s[20:23], s46 offen
    s_branch cv_hend
cv_wd:
    s_mov_b32 s28, s12
    s_mov_b32 s29, s13
    s_mov_b32 s30, 0x1c0000
    s_mov_b32 s31, 0x20000
    v_lshrrev_b32 v14, 3, v2
    v_lshlrev_b32 v14, 10, v14
    v_and_b32 v15, 7, v2
    v_lshl_add_u32 v14, v15, 4, v14
    s_lshr_b32 s84, s2, 1
    s_and_b32 s85, s2, 1
    s_lshl_b32 s86, s84, 14
    s_lshl_b32 s87, s85, 9
    s_add_u32 s86, s86, s87
    s_add_u32 s87, s86, 8192
    buffer_load_dwordx4 v[64:67], v14, s[28:31], s86 offen offset:0
    buffer_load_dwordx4 v[68:71], v14, s[28:31], s87 offen offset:0
    buffer_load_dwordx4 v[72:75], v14, s[28:31], s86 offen offset:128
    buffer_load_dwordx4 v[76:79], v14, s[28:31], s87 offen offset:128
    buffer_load_dwordx4 v[80:83], v14, s[28:31], s86 offen offset:256
    buffer_load_dwordx4 v[84:87], v14, s[28:31], s87 offen offset:256
    buffer_load_dwordx4 v[88:91], v14, s[28:31], s86 offen offset:384
    buffer_load_dwordx4 v[92:95], v14, s[28:31], s87 offen offset:384
    v_add_u32 v12, s66, v6
    v_lshl_add_u32 v28, v26, 2, v24
    v_lshlrev_b32 v28, 7, v28
    v_lshl_add_u32 v28, v27, 5, v28
    v_lshl_add_u32 v28, v25, 3, v28
    v_add_u32 v28, s66, v28
    s_mul_i32 s44, s85, 448
    s_add_u32 s44, s44, s84
    s_lshl_b32 s44, s44, 11
    s_add_u32 s44, s44, 10248192
    s_waitcnt vmcnt(6)
    ds_write_b128 v12, v[64:67] offset:0
    ds_write_b128 v12, v[68:71] offset:1024
    ds_read_b64_tr_b16 v[32:33], v28 offset:0
    ds_read_b64_tr_b16 v[34:35], v28 offset:1024
    ds_read_b64_tr_b16 v[36:37], v28 offset:64
    ds_read_b64_tr_b16 v[38:39], v28 offset:1088
    s_waitcnt lgkmcnt(2)
    buffer_store_dwordx4 v[32:35], v6, s[20:23], s44 offen offset:0 sc1
    s_waitcnt lgkmcnt(0)
    buffer_store_dwordx4 v[36:39], v6, s[20:23], s44 offen offset:1024 sc1
    s_add_u32 s44, s44, 229376
    s_waitcnt vmcnt(6)
    ds_write_b128 v12, v[72:75] offset:2048
    ds_write_b128 v12, v[76:79] offset:3072
    ds_read_b64_tr_b16 v[40:41], v28 offset:2048
    ds_read_b64_tr_b16 v[42:43], v28 offset:3072
    ds_read_b64_tr_b16 v[44:45], v28 offset:2112
    ds_read_b64_tr_b16 v[46:47], v28 offset:3136
    s_waitcnt lgkmcnt(2)
    buffer_store_dwordx4 v[40:43], v6, s[20:23], s44 offen offset:0 sc1
    s_waitcnt lgkmcnt(0)
    buffer_store_dwordx4 v[44:47], v6, s[20:23], s44 offen offset:1024 sc1
    s_add_u32 s44, s44, 229376
    s_waitcnt vmcnt(6)
    ds_write_b128 v12, v[80:83] offset:4096
    ds_write_b128 v12, v[84:87] offset:5120
    ds_read_b64_tr_b16 v[48:49], v28 offset:4096
    ds_read_b64_tr_b16 v[50:51], v28 offset:5120
    ds_read_b64_tr_b16 v[52:53], v28 offset:4160
    ds_read_b64_tr_b16 v[54:55], v28 offset:5184
    s_waitcnt lgkmcnt(2)
    buffer_store_dwordx4 v[48:51], v6, s[20:23], s44 offen offset:0 sc1
    s_waitcnt lgkmcnt(0)
    buffer_store_dwordx4 v[52:55], v6, s[20:23], s44 offen offset:1024 sc1
    s_add_u32 s44, s44, 229376
    s_waitcnt vmcnt(6)
    ds_write_b128 v12, v[88:91] offset:6144
    ds_write_b128 v12, v[92:95] offset:7168
    ds_read_b64_tr_b16 v[56:57], v28 offset:6144
    ds_read_b64_tr_b16 v[58:59], v28 offset:7168
    ds_read_b64_tr_b16 v[60:61], v28 offset:6208
    ds_read_b64_tr_b16 v[62:63], v28 offset:7232
    s_waitcnt lgkmcnt(2)
    buffer_store_dwordx4 v[56:59], v6, s[20:23], s44 offen offset:0 sc1
    s_waitcnt lgkmcnt(0)
    buffer_store_dwordx4 v[60:63], v6, s[20:23], s44 offen offset:1024 sc1
    s_add_u32 s44, s44, 229376
cv_hend:
conv_end:
    s_endpgm
.globl ffn_kernel
.p2align 8
.type ffn_kernel,@function
ffn_kernel:
    s_cmp_ge_u32 s2, 256
    s_cbranch_scc1 ff_end
    s_load_dwordx2 s[4:5], s[0:1], 96
    s_load_dwordx2 s[6:7], s[0:1], 80
    v_lshrrev_b32 v1, 6, v0
    v_and_b32 v2, 63, v0
    v_readfirstlane_b32 s46, v1
    s_and_b32 s21, s2, 1
    s_lshl_b32 s21, s21, 3
    s_bfe_u32 s27, s2, 0x30003
    s_add_u32 s21, s21, s27
    s_bfe_u32 s22, s2, 0x20001
    s_lshl_b32 s22, s22, 2
    s_lshr_b32 s23, s2, 6
    s_add_u32 s22, s22, s23
    s_and_b32 s20, s46, 3
    v_lshlrev_b32 v3, 4, v2
    s_cmp_ge_u32 s46, 4
    s_cbranch_scc1 ff_ld
    v_lshlrev_b32 v9, 1, v0
    v_add_u32 v9, 162816, v9
    v_mov_b32 v8, -1
    ds_write_b16 v9, v8
    v_lshrrev_b32 v16, 4, v2
    v_and_b32 v17, 15, v2
    v_lshrrev_b32 v18, 2, v17
    v_and_b32 v19, 3, v17
    s_waitcnt lgkmcnt(0)
    s_barrier
    v_lshrrev_b32 v20, 1, v16
    v_and_b32 v21, 1, v16
    v_lshl_add_u32 v6, v20, 3, v18
    v_lshlrev_b32 v6, 8, v6
    v_xor_b32 v18, s20, v18
    v_lshl_add_u32 v6, v18, 6, v6
    v_lshl_add_u32 v6, v21, 5, v6
    v_lshl_add_u32 v6, v19, 3, v6
    v_add_u32 v7, 49152, v6
    v_add_u32 v8, 98304, v6
    v_add_u32 v4, 49152, v3
    v_add_u32 v5, 98304, v3
    v_lshlrev_b32 v9, 2, v19
    v_add_u32 v9, 162816, v9
    s_lshl_b32 s37, s21, 2
    s_add_u32 s37, s37, s20
    s_mul_i32 s37, s37, 112
    s_mul_i32 s38, s22, 7
    s_add_u32 s37, s37, s38
    s_lshl_b32 s37, s37, 10
    s_add_u32 s37, s37, 12083200
    s_add_u32 s36, s37, 4096
    s_lshl_b32 s38, s21, 1
    s_lshr_b32 s39, s20, 1
    s_add_u32 s38, s38, s39
    s_lshl_b32 s38, s38, 2
    s_lshr_b32 s39, s22, 2
    s_add_u32 s38, s38, s39
    s_lshl_b32 s38, s38, 5
    s_and_b32 s39, s22, 3
    s_lshl_b32 s39, s39, 1
    s_add_u32 s38, s38, s39
    s_and_b32 s39, s20, 1
    s_add_u32 s38, s38, s39
    s_lshl_b32 s38, s38, 2
    s_add_u32 s38, s38, 4284416
    v_mov_b32 v10, 1
    v_mov_b32 v11, 0
    v_mov_b32 v12, 0
    v_mov_b32 v13, 0
    v_mov_b32 v14, 0
    v_mov_b32 v15, 0
    s_mov_b32 s34, 0xffff0000
    s_mov_b32 s35, 0x3f803f80
    s_mov_b32 s16, s4
    s_mov_b32 s17, s5
    s_mov_b32 s18, 0x1286000
    s_mov_b32 s19, 0x20000
    s_mov_b32 s44, 0
sp_9:
    ds_read_b32 v1, v9 offset:0
    s_add_u32 s44, s44, 1
    s_cmp_gt_u32 s44, 0x100000
    s_cbranch_scc1 spd_10
    s_waitcnt lgkmcnt(0)
    v_cmp_ne_u32 vcc, 0, v1
    s_cbranch_vccnz sp_9
spd_10:
    ds_read_b64_tr_b16 v[128:129], v6 offset:8192
    ds_read_b64_tr_b16 v[130:131], v6 offset:9216
    ds_read_b128 v[32:35], v3 offset:0
    ds_read_b128 v[36:39], v3 offset:1024
    ds_read_b128 v[40:43], v3 offset:2048
    ds_read_b32 v1, v9 offset:16
    ds_read_b64_tr_b16 v[132:133], v6 offset:12288
    ds_read_b64_tr_b16 v[134:135], v6 offset:13312
    ds_read_b128 v[44:47], v3 offset:3072
    ds_read_b128 v[48:51], v3 offset:4096
    ds_read_b128 v[52:55], v3 offset:5120
    s_waitcnt lgkmcnt(6)
    v_mfma_f32_32x32x16_bf16 v[64:79], v[32:35], v[128:131], 0
    s_waitcnt lgkmcnt(5)
    v_cmp_ne_u32 vcc, 0, v1
    s_cbranch_vccnz ff_xs1
ff_xg1:
    ds_read_b128 v[32:35], v3 offset:16384
    ds_read_b64_tr_b16 v[136:137], v6 offset:24576
    v_mfma_f32_32x32x16_bf16 v[80:95], v[36:39], v[128:131], 0
    ds_read_b128 v[36:39], v3 offset:17408
    ds_read_b64_tr_b16 v[138:139], v6 offset:25600
    v_mfma_f32_32x32x16_bf16 v[96:111], v[40:43], v[128:131], 0
    ds_read_b128 v[40:43], v3 offset:18432
    s_waitcnt lgkmcnt(5)
    v_mfma_f32_32x32x16_bf16 v[64:79], v[44:47], v[132:135], v[64:79]
    ds_read_b32 v1, v9 offset:32
    ds_read_b128 v[44:47], v3 offset:19456
    ds_read_b64_tr_b16 v[140:141], v6 offset:28672
    v_mfma_f32_32x32x16_bf16 v[80:95], v[48:51], v[132:135], v[80:95]
    ds_read_b128 v[48:51], v3 offset:20480
    ds_read_b64_tr_b16 v[142:143], v6 offset:29696
    v_mfma_f32_32x32x16_bf16 v[96:111], v[52:55], v[132:135], v[96:111]
    ds_read_b128 v[52:55], v3 offset:21504
    v_dot2c_f32_bf16 v12, s35, v128
    v_dot2c_f32_bf16 v14, v128, v128
    v_dot2c_f32_bf16 v13, s35, v129
    v_dot2c_f32_bf16 v15, v129, v129
    v_dot2c_f32_bf16 v12, s35, v130
    v_dot2c_f32_bf16 v14, v130, v130
    v_dot2c_f32_bf16 v13, s35, v131
    v_dot2c_f32_bf16 v15, v131, v131
    v_dot2c_f32_bf16 v12, s35, v132
    v_dot2c_f32_bf16 v14, v132, v132
    v_dot2c_f32_bf16 v13, s35, v133
    v_dot2c_f32_bf16 v15, v133, v133
    v_dot2c_f32_bf16 v12, s35, v134
    v_dot2c_f32_bf16 v14, v134, v134
    v_dot2c_f32_bf16 v13, s35, v135
    v_dot2c_f32_bf16 v15, v135, v135
    s_waitcnt lgkmcnt(6)
    v_mfma_f32_32x32x16_bf16 v[64:79], v[32:35], v[136:139], v[64:79]
    s_waitcnt lgkmcnt(5)
    v_cmp_ne_u32 vcc, 0, v1
    s_cbranch_vccnz ff_xs2
ff_xg2:
    ds_read_b128 v[32:35], v3 offset:32768
    ds_read_b64_tr_b16 v[144:145], v6 offset:40960
    v_mfma_f32_32x32x16_bf16 v[80:95], v[36:39], v[136:139], v[80:95]
    ds_read_b128 v[36:39], v3 offset:33792
    ds_read_b64_tr_b16 v[146:147], v6 offset:41984
    v_mfma_f32_32x32x16_bf16 v[96:111], v[40:43], v[136:139], v[96:111]
    ds_read_b128 v[40:43], v3 offset:34816
    s_waitcnt lgkmcnt(5)
    v_mfma_f32_32x32x16_bf16 v[64:79], v[44:47], v[140:143], v[64:79]
    ds_read_b32 v1, v9 offset:48
    ds_read_b128 v[44:47], v3 offset:35840
    ds_read_b64_tr_b16 v[148:149], v6 offset:45056
    v_mfma_f32_32x32x16_bf16 v[80:95], v[48:51], v[140:143], v[80:95]
    ds_read_b128 v[48:51], v3 offset:36864
    ds_read_b64_tr_b16 v[150:151], v6 offset:46080
    v_mfma_f32_32x32x16_bf16 v[96:111], v[52:55], v[140:143], v[96:111]
    ds_read_b128 v[52:55], v3 offset:37888
    v_dot2c_f32_bf16 v12, s35, v136
    v_dot2c_f32_bf16 v14, v136, v136
    v_dot2c_f32_bf16 v13, s35, v137
    v_dot2c_f32_bf16 v15, v137, v137
    v_dot2c_f32_bf16 v12, s35, v138
    v_dot2c_f32_bf16 v14, v138, v138
    v_dot2c_f32_bf16 v13, s35, v139
    v_dot2c_f32_bf16 v15, v139, v139
    v_dot2c_f32_bf16 v12, s35, v140
    v_dot2c_f32_bf16 v14, v140, v140
    v_dot2c_f32_bf16 v13, s35, v141
    v_dot2c_f32_bf16 v15, v141, v141
    v_dot2c_f32_bf16 v12, s35, v142
    v_dot2c_f32_bf16 v14, v142, v142
    v_dot2c_f32_bf16 v13, s35, v143
    v_dot2c_f32_bf16 v15, v143, v143
    s_waitcnt lgkmcnt(6)
    v_mfma_f32_32x32x16_bf16 v[64:79], v[32:35], v[144:147], v[64:79]
    s_waitcnt lgkmcnt(5)
    v_cmp_ne_u32 vcc, 0, v1
    s_cbranch_vccnz ff_xs3
ff_xg3:
    ds_read_b128 v[32:35], v4 offset:0
    ds_read_b64_tr_b16 v[152:153], v7 offset:8192
    v_mfma_f32_32x32x16_bf16 v[80:95], v[36:39], v[144:147], v[80:95]
    ds_read_b128 v[36:39], v4 offset:1024
    ds_read_b64_tr_b16 v[154:155], v7 offset:9216
    v_mfma_f32_32x32x16_bf16 v[96:111], v[40:43], v[144:147], v[96:111]
    ds_read_b128 v[40:43], v4 offset:2048
    s_waitcnt lgkmcnt(5)
    v_mfma_f32_32x32x16_bf16 v[64:79], v[44:47], v[148:151], v[64:79]
    ds_read_b32 v1, v9 offset:64
    ds_read_b128 v[44:47], v4 offset:3072
    ds_read_b64_tr_b16 v[156:157], v7 offset:12288
    v_mfma_f32_32x32x16_bf16 v[80:95], v[48:51], v[148:151], v[80:95]
    ds_read_b128 v[48:51], v4 offset:4096
    ds_read_b64_tr_b16 v[158:159], v7 offset:13312
    v_mfma_f32_32x32x16_bf16 v[96:111], v[52:55], v[148:151], v[96:111]
    ds_read_b128 v[52:55], v4 offset:5120
    v_dot2c_f32_bf16 v12, s35, v144
    v_dot2c_f32_bf16 v14, v144, v144
    v_dot2c_f32_bf16 v13, s35, v145
    v_dot2c_f32_bf16 v15, v145, v145
    v_dot2c_f32_bf16 v12, s35, v146
    v_dot2c_f32_bf16 v14, v146, v146
    v_dot2c_f32_bf16 v13, s35, v147
    v_dot2c_f32_bf16 v15, v147, v147
    v_dot2c_f32_bf16 v12, s35, v148
    v_dot2c_f32_bf16 v14, v148, v148
    v_dot2c_f32_bf16 v13, s35, v149
    v_dot2c_f32_bf16 v15, v149, v149
    v_dot2c_f32_bf16 v12, s35, v150
    v_dot2c_f32_bf16 v14, v150, v150
    v_dot2c_f32_bf16 v13, s35, v151
    v_dot2c_f32_bf16 v15, v151, v151
    s_waitcnt lgkmcnt(6)
    v_mfma_f32_32x32x16_bf16 v[64:79], v[32:35], v[152:155], v[64:79]
    s_waitcnt lgkmcnt(5)
    v_cmp_ne_u32 vcc, 0, v1
    s_cbranch_vccnz ff_xs4
ff_xg4:
    ds_read_b128 v[32:35], v4 offset:16384
    ds_read_b64_tr_b16 v[160:161], v7 offset:24576
    v_mfma_f32_32x32x16_bf16 v[80:95], v[36:39], v[152:155], v[80:95]
    ds_read_b128 v[36:39], v4 offset:17408
    ds_read_b64_tr_b16 v[162:163], v7 offset:25600
    v_mfma_f32_32x32x16_bf16 v[96:111], v[40:43], v[152:155], v[96:111]
    ds_read_b128 v[40:43], v4 offset:18432
    s_waitcnt lgkmcnt(5)
    v_mfma_f32_32x32x16_bf16 v[64:79], v[44:47], v[156:159], v[64:79]
    ds_read_b32 v1, v9 offset:80
    ds_read_b128 v[44:47], v4 offset:19456
    ds_read_b64_tr_b16 v[164:165], v7 offset:28672
    v_mfma_f32_32x32x16_bf16 v[80:95], v[48:51], v[156:159], v[80:95]
    ds_read_b128 v[48:51], v4 offset:20480
    ds_read_b64_tr_b16 v[166:167], v7 offset:29696
    v_mfma_f32_32x32x16_bf16 v[96:111], v[52:55], v[156:159], v[96:111]
    ds_read_b128 v[52:55], v4 offset:21504
    v_dot2c_f32_bf16 v12, s35, v152
    v_dot2c_f32_bf16 v14, v152, v152
    v_dot2c_f32_bf16 v13, s35, v153
    v_dot2c_f32_bf16 v15, v153, v153
    v_dot2c_f32_bf16 v12, s35, v154
    v_dot2c_f32_bf16 v14, v154, v154
    v_dot2c_f32_bf16 v13, s35, v155
    v_dot2c_f32_bf16 v15, v155, v155
    v_dot2c_f32_bf16 v12, s35, v156
    v_dot2c_f32_bf16 v14, v156, v156
    v_dot2c_f32_bf16 v13, s35, v157
    v_dot2c_f32_bf16 v15, v157, v157
    v_dot2c_f32_bf16 v12, s35, v158
    v_dot2c_f32_bf16 v14, v158, v158
    v_dot2c_f32_bf16 v13, s35, v159
    v_dot2c_f32_bf16 v15, v159, v159
    s_waitcnt lgkmcnt(6)
    v_mfma_f32_32x32x16_bf16 v[64:79], v[32:35], v[160:163], v[64:79]
    s_waitcnt lgkmcnt(5)
    v_cmp_ne_u32 vcc, 0, v1
    s_cbranch_vccnz ff_xs5
ff_xg5:
    ds_read_b128 v[32:35], v4 offset:32768
    ds_read_b64_tr_b16 v[168:169], v7 offset:40960
    v_mfma_f32_32x32x16_bf16 v[80:95], v[36:39], v[160:163], v[80:95]
    s_barrier
    ds_read_b128 v[36:39], v4 offset:33792
    ds_read_b64_tr_b16 v[170:171], v7 offset:41984
    v_mfma_f32_32x32x16_bf16 v[96:111], v[40:43], v[160:163], v[96:111]
    ds_read_b128 v[40:43], v4 offset:34816
    s_waitcnt lgkmcnt(5)
    v_mfma_f32_32x32x16_bf16 v[64:79], v[44:47], v[164:167], v[64:79]
    ds_read_b32 v1, v9 offset:96
    ds_read_b128 v[44:47], v4 offset:35840
    ds_read_b64_tr_b16 v[172:173], v7 offset:45056
    v_mfma_f32_32x32x16_bf16 v[80:95], v[48:51], v[164:167], v[80:95]
    ds_read_b128 v[48:51], v4 offset:36864
    ds_read_b64_tr_b16 v[174:175], v7 offset:46080
    v_mfma_f32_32x32x16_bf16 v[96:111], v[52:55], v[164:167], v[96:111]
    ds_read_b128 v[52:55], v4 offset:37888
    v_dot2c_f32_bf16 v12, s35, v160
    v_dot2c_f32_bf16 v14, v160, v160
    v_dot2c_f32_bf16 v13, s35, v161
    v_dot2c_f32_bf16 v15, v161, v161
    v_dot2c_f32_bf16 v12, s35, v162
    v_dot2c_f32_bf16 v14, v162, v162
    v_dot2c_f32_bf16 v13, s35, v163
    v_dot2c_f32_bf16 v15, v163, v163
    v_dot2c_f32_bf16 v12, s35, v164
    v_dot2c_f32_bf16 v14, v164, v164
    v_dot2c_f32_bf16 v13, s35, v165
    v_dot2c_f32_bf16 v15, v165, v165
    v_dot2c_f32_bf16 v12, s35, v166
    v_dot2c_f32_bf16 v14, v166, v166
    v_dot2c_f32_bf16 v13, s35, v167
    v_dot2c_f32_bf16 v15, v167, v167
    s_waitcnt lgkmcnt(6)
    v_mfma_f32_32x32x16_bf16 v[64:79], v[32:35], v[168:171], v[64:79]
    s_waitcnt lgkmcnt(5)
    v_cmp_ne_u32 vcc, 0, v1
    s_cbranch_vccnz ff_xs6
ff_xg6:
    ds_read_b128 v[32:35], v5 offset:0
    ds_read_b64_tr_b16 v[176:177], v8 offset:8192
    v_mfma_f32_32x32x16_bf16 v[80:95], v[36:39], v[168:171], v[80:95]
    ds_read_b128 v[36:39], v5 offset:1024
    ds_read_b64_tr_b16 v[178:179], v8 offset:9216
    v_mfma_f32_32x32x16_bf16 v[96:111], v[40:43], v[168:171], v[96:111]
    ds_read_b128 v[40:43], v5 offset:2048
    s_waitcnt lgkmcnt(5)
    v_mfma_f32_32x32x16_bf16 v[64:79], v[44:47], v[172:175], v[64:79]
    ds_read_b32 v1, v9 offset:112
    ds_read_b128 v[44:47], v5 offset:3072
    ds_read_b64_tr_b16 v[180:181], v8 offset:12288
    v_mfma_f32_32x32x16_bf16 v[80:95], v[48:51], v[172:175], v[80:95]
    ds_read_b128 v[48:51], v5 offset:4096
    ds_read_b64_tr_b16 v[182:183], v8 offset:13312
    v_mfma_f32_32x32x16_bf16 v[96:111], v[52:55], v[172:175], v[96:111]
    ds_read_b128 v[52:55], v5 offset:5120
    v_dot2c_f32_bf16 v12, s35, v168
    v_dot2c_f32_bf16 v14, v168, v168
    v_dot2c_f32_bf16 v13, s35, v169
    v_dot2c_f32_bf16 v15, v169, v169
    v_dot2c_f32_bf16 v12, s35, v170
    v_dot2c_f32_bf16 v14, v170, v170
    v_dot2c_f32_bf16 v13, s35, v171
    v_dot2c_f32_bf16 v15, v171, v171
    v_dot2c_f32_bf16 v12, s35, v172
    v_dot2c_f32_bf16 v14, v172, v172
    v_dot2c_f32_bf16 v13, s35, v173
    v_dot2c_f32_bf16 v15, v173, v173
    v_dot2c_f32_bf16 v12, s35, v174
    v_dot2c_f32_bf16 v14, v174, v174
    v_dot2c_f32_bf16 v13, s35, v175
    v_dot2c_f32_bf16 v15, v175, v175
    s_waitcnt lgkmcnt(6)
    v_mfma_f32_32x32x16_bf16 v[64:79], v[32:35], v[176:179], v[64:79]
    s_waitcnt lgkmcnt(5)
    v_cmp_ne_u32 vcc, 0, v1
    s_cbranch_vccnz ff_xs7
ff_xg7:
    ds_read_b128 v[32:35], v5 offset:16384
    ds_read_b64_tr_b16 v[184:185], v8 offset:24576
    v_mfma_f32_32x32x16_bf16 v[80:95], v[36:39], v[176:179], v[80:95]
    ds_read_b128 v[36:39], v5 offset:17408
    ds_read_b64_tr_b16 v[186:187], v8 offset:25600
    v_mfma_f32_32x32x16_bf16 v[96:111], v[40:43], v[176:179], v[96:111]
    ds_read_b128 v[40:43], v5 offset:18432
    s_waitcnt lgkmcnt(5)
    v_mfma_f32_32x32x16_bf16 v[64:79], v[44:47], v[180:183], v[64:79]
    ds_read_b32 v1, v9 offset:128
    ds_read_b128 v[44:47], v5 offset:19456
    ds_read_b64_tr_b16 v[188:189], v8 offset:28672
    v_mfma_f32_32x32x16_bf16 v[80:95], v[48:51], v[180:183], v[80:95]
    ds_read_b128 v[48:51], v5 offset:20480
    ds_read_b64_tr_b16 v[190:191], v8 offset:29696
    v_mfma_f32_32x32x16_bf16 v[96:111], v[52:55], v[180:183], v[96:111]
    ds_read_b128 v[52:55], v5 offset:21504
    v_dot2c_f32_bf16 v12, s35, v176
    v_dot2c_f32_bf16 v14, v176, v176
    v_dot2c_f32_bf16 v13, s35, v177
    v_dot2c_f32_bf16 v15, v177, v177
    v_dot2c_f32_bf16 v12, s35, v178
    v_dot2c_f32_bf16 v14, v178, v178
    v_dot2c_f32_bf16 v13, s35, v179
    v_dot2c_f32_bf16 v15, v179, v179
    v_dot2c_f32_bf16 v12, s35, v180
    v_dot2c_f32_bf16 v14, v180, v180
    v_dot2c_f32_bf16 v13, s35, v181
    v_dot2c_f32_bf16 v15, v181, v181
    v_dot2c_f32_bf16 v12, s35, v182
    v_dot2c_f32_bf16 v14, v182, v182
    v_dot2c_f32_bf16 v13, s35, v183
    v_dot2c_f32_bf16 v15, v183, v183
    s_waitcnt lgkmcnt(6)
    v_mfma_f32_32x32x16_bf16 v[64:79], v[32:35], v[184:187], v[64:79]
    s_waitcnt lgkmcnt(5)
    v_cmp_ne_u32 vcc, 0, v1
    s_cbranch_vccnz ff_xs8
ff_xg8:
    ds_read_b128 v[32:35], v5 offset:32768
    ds_read_b64_tr_b16 v[192:193], v8 offset:40960
    v_mfma_f32_32x32x16_bf16 v[80:95], v[36:39], v[184:187], v[80:95]
    ds_read_b128 v[36:39], v5 offset:33792
    ds_read_b64_tr_b16 v[194:195], v8 offset:41984
    v_mfma_f32_32x32x16_bf16 v[96:111], v[40:43], v[184:187], v[96:111]
    ds_read_b128 v[40:43], v5 offset:34816
    s_waitcnt lgkmcnt(5)
    v_mfma_f32_32x32x16_bf16 v[64:79], v[44:47], v[188:191], v[64:79]
    ds_read_b32 v1, v9 offset:144
    ds_read_b128 v[44:47], v5 offset:35840
    ds_read_b64_tr_b16 v[196:197], v8 offset:45056
    v_mfma_f32_32x32x16_bf16 v[80:95], v[48:51], v[188:191], v[80:95]
    ds_read_b128 v[48:51], v5 offset:36864
    ds_read_b64_tr_b16 v[198:199], v8 offset:46080
    v_mfma_f32_32x32x16_bf16 v[96:111], v[52:55], v[188:191], v[96:111]
    ds_read_b128 v[52:55], v5 offset:37888
    v_dot2c_f32_bf16 v12, s35, v184
    v_dot2c_f32_bf16 v14, v184, v184
    v_dot2c_f32_bf16 v13, s35, v185
    v_dot2c_f32_bf16 v15, v185, v185
    v_dot2c_f32_bf16 v12, s35, v186
    v_dot2c_f32_bf16 v14, v186, v186
    v_dot2c_f32_bf16 v13, s35, v187
    v_dot2c_f32_bf16 v15, v187, v187
    v_dot2c_f32_bf16 v12, s35, v188
    v_dot2c_f32_bf16 v14, v188, v188
    v_dot2c_f32_bf16 v13, s35, v189
    v_dot2c_f32_bf16 v15, v189, v189
    v_dot2c_f32_bf16 v12, s35, v190
    v_dot2c_f32_bf16 v14, v190, v190
    v_dot2c_f32_bf16 v13, s35, v191
    v_dot2c_f32_bf16 v15, v191, v191
    s_waitcnt lgkmcnt(6)
    v_mfma_f32_32x32x16_bf16 v[64:79], v[32:35], v[192:195], v[64:79]
    s_waitcnt lgkmcnt(5)
    v_cmp_ne_u32 vcc, 0, v1
    s_cbranch_vccnz ff_xs9
ff_xg9:
    ds_read_b128 v[32:35], v3 offset:0
    ds_read_b64_tr_b16 v[200:201], v6 offset:8192
    v_mfma_f32_32x32x16_bf16 v[80:95], v[36:39], v[192:195], v[80:95]
    s_barrier
    ds_read_b128 v[36:39], v3 offset:1024
    ds_read_b64_tr_b16 v[202:203], v6 offset:9216
    v_mfma_f32_32x32x16_bf16 v[96:111], v[40:43], v[192:195], v[96:111]
    ds_read_b128 v[40:43], v3 offset:2048
    s_waitcnt lgkmcnt(5)
    v_mfma_f32_32x32x16_bf16 v[64:79], v[44:47], v[196:199], v[64:79]
    ds_read_b32 v1, v9 offset:160
    ds_read_b128 v[44:47], v3 offset:3072
    ds_read_b64_tr_b16 v[204:205], v6 offset:12288
    v_mfma_f32_32x32x16_bf16 v[80:95], v[48:51], v[196:199], v[80:95]
    ds_read_b128 v[48:51], v3 offset:4096
    ds_read_b64_tr_b16 v[206:207], v6 offset:13312
    v_mfma_f32_32x32x16_bf16 v[96:111], v[52:55], v[196:199], v[96:111]
    ds_read_b128 v[52:55], v3 offset:5120
    v_dot2c_f32_bf16 v12, s35, v192
    v_dot2c_f32_bf16 v14, v192, v192
    v_dot2c_f32_bf16 v13, s35, v193
    v_dot2c_f32_bf16 v15, v193, v193
    v_dot2c_f32_bf16 v12, s35, v194
    v_dot2c_f32_bf16 v14, v194, v194
    v_dot2c_f32_bf16 v13, s35, v195
    v_dot2c_f32_bf16 v15, v195, v195
    v_dot2c_f32_bf16 v12, s35, v196
    v_dot2c_f32_bf16 v14, v196, v196
    v_dot2c_f32_bf16 v13, s35, v197
    v_dot2c_f32_bf16 v15, v197, v197
    v_dot2c_f32_bf16 v12, s35, v198
    v_dot2c_f32_bf16 v14, v198, v198
    v_dot2c_f32_bf16 v13, s35, v199
    v_dot2c_f32_bf16 v15, v199, v199
    s_waitcnt lgkmcnt(6)
    v_mfma_f32_32x32x16_bf16 v[64:79], v[32:35], v[200:203], v[64:79]
    s_waitcnt lgkmcnt(5)
    v_cmp_ne_u32 vcc, 0, v1
    s_cbranch_vccnz ff_xs10
ff_xg10:
    ds_read_b128 v[32:35], v3 offset:16384
    ds_read_b64_tr_b16 v[208:209], v6 offset:24576
    v_mfma_f32_32x32x16_bf16 v[80:95], v[36:39], v[200:203], v[80:95]
    ds_read_b128 v[36:39], v3 offset:17408
    ds_read_b64_tr_b16 v[210:211], v6 offset:25600
    v_mfma_f32_32x32x16_bf16 v[96:111], v[40:43], v[200:203], v[96:111]
    ds_read_b128 v[40:43], v3 offset:18432
    s_waitcnt lgkmcnt(5)
    v_mfma_f32_32x32x16_bf16 v[64:79], v[44:47], v[204:207], v[64:79]
    ds_read_b32 v1, v9 offset:176
    ds_read_b128 v[44:47], v3 offset:19456
    ds_read_b64_tr_b16 v[212:213], v6 offset:28672
    v_mfma_f32_32x32x16_bf16 v[80:95], v[48:51], v[204:207], v[80:95]
    ds_read_b128 v[48:51], v3 offset:20480
    ds_read_b64_tr_b16 v[214:215], v6 offset:29696
    v_mfma_f32_32x32x16_bf16 v[96:111], v[52:55], v[204:207], v[96:111]
    ds_read_b128 v[52:55], v3 offset:21504
    v_dot2c_f32_bf16 v12, s35, v200
    v_dot2c_f32_bf16 v14, v200, v200
    v_dot2c_f32_bf16 v13, s35, v201
    v_dot2c_f32_bf16 v15, v201, v201
    v_dot2c_f32_bf16 v12, s35, v202
    v_dot2c_f32_bf16 v14, v202, v202
    v_dot2c_f32_bf16 v13, s35, v203
    v_dot2c_f32_bf16 v15, v203, v203
    v_dot2c_f32_bf16 v12, s35, v204
    v_dot2c_f32_bf16 v14, v204, v204
    v_dot2c_f32_bf16 v13, s35, v205
    v_dot2c_f32_bf16 v15, v205, v205
    v_dot2c_f32_bf16 v12, s35, v206
    v_dot2c_f32_bf16 v14, v206, v206
    v_dot2c_f32_bf16 v13, s35, v207
    v_dot2c_f32_bf16 v15, v207, v207
    s_waitcnt lgkmcnt(6)
    v_mfma_f32_32x32x16_bf16 v[64:79], v[32:35], v[208:211], v[64:79]
    s_waitcnt lgkmcnt(5)
    v_cmp_ne_u32 vcc, 0, v1
    s_cbranch_vccnz ff_xs11
ff_xg11:
    ds_read_b128 v[32:35], v3 offset:32768
    ds_read_b64_tr_b16 v[216:217], v6 offset:40960
    v_mfma_f32_32x32x16_bf16 v[80:95], v[36:39], v[208:211], v[80:95]
    ds_read_b128 v[36:39], v3 offset:33792
    ds_read_b64_tr_b16 v[218:219], v6 offset:41984
    v_mfma_f32_32x32x16_bf16 v[96:111], v[40:43], v[208:211], v[96:111]
    ds_read_b128 v[40:43], v3 offset:34816
    s_waitcnt lgkmcnt(5)
    v_mfma_f32_32x32x16_bf16 v[64:79], v[44:47], v[212:215], v[64:79]
    ds_read_b32 v1, v9 offset:192
    ds_read_b128 v[44:47], v3 offset:35840
    ds_read_b64_tr_b16 v[220:221], v6 offset:45056
    v_mfma_f32_32x32x16_bf16 v[80:95], v[48:51], v[212:215], v[80:95]
    ds_read_b128 v[48:51], v3 offset:36864
    ds_read_b64_tr_b16 v[222:223], v6 offset:46080
    v_mfma_f32_32x32x16_bf16 v[96:111], v[52:55], v[212:215], v[96:111]
    ds_read_b128 v[52:55], v3 offset:37888
    v_dot2c_f32_bf16 v12, s35, v208
    v_dot2c_f32_bf16 v14, v208, v208
    v_dot2c_f32_bf16 v13, s35, v209
    v_dot2c_f32_bf16 v15, v209, v209
    v_dot2c_f32_bf16 v12, s35, v210
    v_dot2c_f32_bf16 v14, v210, v210
    v_dot2c_f32_bf16 v13, s35, v211
    v_dot2c_f32_bf16 v15, v211, v211
    v_dot2c_f32_bf16 v12, s35, v212
    v_dot2c_f32_bf16 v14, v212, v212
    v_dot2c_f32_bf16 v13, s35, v213
    v_dot2c_f32_bf16 v15, v213, v213
    v_dot2c_f32_bf16 v12, s35, v214
    v_dot2c_f32_bf16 v14, v214, v214
    v_dot2c_f32_bf16 v13, s35, v215
    v_dot2c_f32_bf16 v15, v215, v215
    s_waitcnt lgkmcnt(6)
    v_mfma_f32_32x32x16_bf16 v[64:79], v[32:35], v[216:219], v[64:79]
    s_waitcnt lgkmcnt(5)
    v_cmp_ne_u32 vcc, 0, v1
    s_cbranch_vccnz ff_xs12
ff_xg12:
    ds_read_b128 v[32:35], v4 offset:0
    ds_read_b64_tr_b16 v[224:225], v7 offset:8192
    v_mfma_f32_32x32x16_bf16 v[80:95], v[36:39], v[216:219], v[80:95]
    ds_read_b128 v[36:39], v4 offset:1024
    ds_read_b64_tr_b16 v[226:227], v7 offset:9216
    v_mfma_f32_32x32x16_bf16 v[96:111], v[40:43], v[216:219], v[96:111]
    ds_read_b128 v[40:43], v4 offset:2048
    s_waitcnt lgkmcnt(5)
    v_mfma_f32_32x32x16_bf16 v[64:79], v[44:47], v[220:223], v[64:79]
    ds_read_b32 v1, v9 offset:208
    ds_read_b128 v[44:47], v4 offset:3072
    ds_read_b64_tr_b16 v[228:229], v7 offset:12288
    v_mfma_f32_32x32x16_bf16 v[80:95], v[48:51], v[220:223], v[80:95]
    ds_read_b128 v[48:51], v4 offset:4096
    ds_read_b64_tr_b16 v[230:231], v7 offset:13312
    v_mfma_f32_32x32x16_bf16 v[96:111], v[52:55], v[220:223], v[96:111]
    ds_read_b128 v[52:55], v4 offset:5120
    v_dot2c_f32_bf16 v12, s35, v216
    v_dot2c_f32_bf16 v14, v216, v216
    v_dot2c_f32_bf16 v13, s35, v217
    v_dot2c_f32_bf16 v15, v217, v217
    v_dot2c_f32_bf16 v12, s35, v218
    v_dot2c_f32_bf16 v14, v218, v218
    v_dot2c_f32_bf16 v13, s35, v219
    v_dot2c_f32_bf16 v15, v219, v219
    v_dot2c_f32_bf16 v12, s35, v220
    v_dot2c_f32_bf16 v14, v220, v220
    v_dot2c_f32_bf16 v13, s35, v221
    v_dot2c_f32_bf16 v15, v221, v221
    v_dot2c_f32_bf16 v12, s35, v222
    v_dot2c_f32_bf16 v14, v222, v222
    v_dot2c_f32_bf16 v13, s35, v223
    v_dot2c_f32_bf16 v15, v223, v223
    s_waitcnt lgkmcnt(6)
    v_mfma_f32_32x32x16_bf16 v[64:79], v[32:35], v[224:227], v[64:79]
    s_waitcnt lgkmcnt(5)
    v_cmp_ne_u32 vcc, 0, v1
    s_cbranch_vccnz ff_xs13
ff_xg13:
    ds_read_b128 v[32:35], v4 offset:16384
    ds_read_b64_tr_b16 v[232:233], v7 offset:24576
    v_mfma_f32_32x32x16_bf16 v[80:95], v[36:39], v[224:227], v[80:95]
    s_barrier
    ds_read_b128 v[36:39], v4 offset:17408
    ds_read_b64_tr_b16 v[234:235], v7 offset:25600
    v_mfma_f32_32x32x16_bf16 v[96:111], v[40:43], v[224:227], v[96:111]
    ds_read_b128 v[40:43], v4 offset:18432
    s_waitcnt lgkmcnt(5)
    v_mfma_f32_32x32x16_bf16 v[64:79], v[44:47], v[228:231], v[64:79]
    ds_read_b32 v1, v9 offset:224
    ds_read_b128 v[44:47], v4 offset:19456
    ds_read_b64_tr_b16 v[236:237], v7 offset:28672
    v_mfma_f32_32x32x16_bf16 v[80:95], v[48:51], v[228:231], v[80:95]
    ds_read_b128 v[48:51], v4 offset:20480
    ds_read_b64_tr_b16 v[238:239], v7 offset:29696
    v_mfma_f32_32x32x16_bf16 v[96:111], v[52:55], v[228:231], v[96:111]
    ds_read_b128 v[52:55], v4 offset:21504
    v_dot2c_f32_bf16 v12, s35, v224
    v_dot2c_f32_bf16 v14, v224, v224
    v_dot2c_f32_bf16 v13, s35, v225
    v_dot2c_f32_bf16 v15, v225, v225
    v_dot2c_f32_bf16 v12, s35, v226
    v_dot2c_f32_bf16 v14, v226, v226
    v_dot2c_f32_bf16 v13, s35, v227
    v_dot2c_f32_bf16 v15, v227, v227
    v_dot2c_f32_bf16 v12, s35, v228
    v_dot2c_f32_bf16 v14, v228, v228
    v_dot2c_f32_bf16 v13, s35, v229
    v_dot2c_f32_bf16 v15, v229, v229
    v_dot2c_f32_bf16 v12, s35, v230
    v_dot2c_f32_bf16 v14, v230, v230
    v_dot2c_f32_bf16 v13, s35, v231
    v_dot2c_f32_bf16 v15, v231, v231
    s_waitcnt lgkmcnt(6)
    v_mfma_f32_32x32x16_bf16 v[64:79], v[32:35], v[232:235], v[64:79]
    s_waitcnt lgkmcnt(5)
    v_cmp_ne_u32 vcc, 0, v1
    s_cbranch_vccnz ff_xs14
ff_xg14:
    ds_read_b128 v[32:35], v4 offset:32768
    ds_read_b64_tr_b16 v[240:241], v7 offset:40960
    v_mfma_f32_32x32x16_bf16 v[80:95], v[36:39], v[232:235], v[80:95]
    ds_read_b128 v[36:39], v4 offset:33792
    ds_read_b64_tr_b16 v[242:243], v7 offset:41984
    v_mfma_f32_32x32x16_bf16 v[96:111], v[40:43], v[232:235], v[96:111]
    ds_read_b128 v[40:43], v4 offset:34816
    s_waitcnt lgkmcnt(5)
    v_mfma_f32_32x32x16_bf16 v[64:79], v[44:47], v[236:239], v[64:79]
    ds_read_b32 v1, v9 offset:240
    ds_read_b128 v[44:47], v4 offset:35840
    ds_read_b64_tr_b16 v[244:245], v7 offset:45056
    v_mfma_f32_32x32x16_bf16 v[80:95], v[48:51], v[236:239], v[80:95]
    ds_read_b128 v[48:51], v4 offset:36864
    ds_read_b64_tr_b16 v[246:247], v7 offset:46080
    v_mfma_f32_32x32x16_bf16 v[96:111], v[52:55], v[236:239], v[96:111]
    ds_read_b128 v[52:55], v4 offset:37888
    v_dot2c_f32_bf16 v12, s35, v232
    v_dot2c_f32_bf16 v14, v232, v232
    v_dot2c_f32_bf16 v13, s35, v233
    v_dot2c_f32_bf16 v15, v233, v233
    v_dot2c_f32_bf16 v12, s35, v234
    v_dot2c_f32_bf16 v14, v234, v234
    v_dot2c_f32_bf16 v13, s35, v235
    v_dot2c_f32_bf16 v15, v235, v235
    v_dot2c_f32_bf16 v12, s35, v236
    v_dot2c_f32_bf16 v14, v236, v236
    v_dot2c_f32_bf16 v13, s35, v237
    v_dot2c_f32_bf16 v15, v237, v237
    v_dot2c_f32_bf16 v12, s35, v238
    v_dot2c_f32_bf16 v14, v238, v238
    v_dot2c_f32_bf16 v13, s35, v239
    v_dot2c_f32_bf16 v15, v239, v239
    s_waitcnt lgkmcnt(6)
    v_mfma_f32_32x32x16_bf16 v[64:79], v[32:35], v[240:243], v[64:79]
    s_waitcnt lgkmcnt(5)
    v_cmp_ne_u32 vcc, 0, v1
    s_cbranch_vccnz ff_xs15
ff_xg15:
    ds_read_b128 v[32:35], v5 offset:0
    ds_read_b64_tr_b16 v[248:249], v8 offset:8192
    v_mfma_f32_32x32x16_bf16 v[80:95], v[36:39], v[240:243], v[80:95]
    s_barrier
    ds_read_b128 v[36:39], v5 offset:1024
    ds_read_b64_tr_b16 v[250:251], v8 offset:9216
    v_mfma_f32_32x32x16_bf16 v[96:111], v[40:43], v[240:243], v[96:111]
    ds_read_b128 v[40:43], v5 offset:2048
    s_waitcnt lgkmcnt(5)
    v_mfma_f32_32x32x16_bf16 v[64:79], v[44:47], v[244:247], v[64:79]
    ds_read_b32 v1, v9 offset:256
    ds_read_b128 v[44:47], v5 offset:3072
    ds_read_b64_tr_b16 v[252:253], v8 offset:12288
    v_mfma_f32_32x32x16_bf16 v[80:95], v[48:51], v[244:247], v[80:95]
    ds_read_b128 v[48:51], v5 offset:4096
    ds_read_b64_tr_b16 v[254:255], v8 offset:13312
    v_mfma_f32_32x32x16_bf16 v[96:111], v[52:55], v[244:247], v[96:111]
    ds_read_b128 v[52:55], v5 offset:5120
    v_dot2c_f32_bf16 v12, s35, v240
    v_dot2c_f32_bf16 v14, v240, v240
    v_dot2c_f32_bf16 v13, s35, v241
    v_dot2c_f32_bf16 v15, v241, v241
    v_dot2c_f32_bf16 v12, s35, v242
    v_dot2c_f32_bf16 v14, v242, v242
    v_dot2c_f32_bf16 v13, s35, v243
    v_dot2c_f32_bf16 v15, v243, v243
    v_dot2c_f32_bf16 v12, s35, v244
    v_dot2c_f32_bf16 v14, v244, v244
    v_dot2c_f32_bf16 v13, s35, v245
    v_dot2c_f32_bf16 v15, v245, v245
    v_dot2c_f32_bf16 v12, s35, v246
    v_dot2c_f32_bf16 v14, v246, v246
    v_dot2c_f32_bf16 v13, s35, v247
    v_dot2c_f32_bf16 v15, v247, v247
    s_waitcnt lgkmcnt(6)
    v_mfma_f32_32x32x16_bf16 v[64:79], v[32:35], v[248:251], v[64:79]
    s_waitcnt lgkmcnt(5)
    v_cmp_ne_u32 vcc, 0, v1
    s_cbranch_vccnz ff_xs16
ff_xg16:
    ds_read_b128 v[56:59], v5 offset:16384
    ds_read_b128 v[60:63], v5 offset:17408
    v_mfma_f32_32x32x16_bf16 v[80:95], v[36:39], v[248:251], v[80:95]
    ds_read_b128 v[24:27], v5 offset:18432
    v_mfma_f32_32x32x16_bf16 v[96:111], v[40:43], v[248:251], v[96:111]
    ds_read_b128 v[28:31], v5 offset:19456
    s_waitcnt lgkmcnt(4)
    v_mfma_f32_32x32x16_bf16 v[64:79], v[44:47], v[252:255], v[64:79]
    ds_read_b128 v[32:35], v5 offset:20480
    ds_read_b128 v[36:39], v5 offset:21504
    v_mfma_f32_32x32x16_bf16 v[80:95], v[48:51], v[252:255], v[80:95]
    ds_read_b128 v[40:43], v5 offset:22528
    v_mfma_f32_32x32x16_bf16 v[96:111], v[52:55], v[252:255], v[96:111]
    ds_read_b128 v[44:47], v5 offset:23552
    v_dot2c_f32_bf16 v12, s35, v248
    v_dot2c_f32_bf16 v14, v248, v248
    v_dot2c_f32_bf16 v13, s35, v249
    v_dot2c_f32_bf16 v15, v249, v249
    v_dot2c_f32_bf16 v12, s35, v250
    v_dot2c_f32_bf16 v14, v250, v250
    v_dot2c_f32_bf16 v13, s35, v251
    v_dot2c_f32_bf16 v15, v251, v251
    v_dot2c_f32_bf16 v12, s35, v252
    v_dot2c_f32_bf16 v14, v252, v252
    v_dot2c_f32_bf16 v13, s35, v253
    v_dot2c_f32_bf16 v15, v253, v253
    v_dot2c_f32_bf16 v12, s35, v254
    v_dot2c_f32_bf16 v14, v254, v254
    v_dot2c_f32_bf16 v13, s35, v255
    v_dot2c_f32_bf16 v15, v255, v255
    s_nop 2
    s_waitcnt lgkmcnt(6)
    v_mfma_f32_32x32x16_bf16 v[112:127], v[56:59], v[128:131], 0
    ds_read_b128 v[48:51], v5 offset:49152
    v_add_f32 v16, v12, v13
    v_add_f32 v18, v14, v15
    v_mov_b32 v17, v16
    v_mov_b32 v19, v18
    v_mfma_f32_32x32x16_bf16 v[112:127], v[60:63], v[132:135], v[112:127]
    s_barrier
    ds_read_b128 v[52:55], v5 offset:50176
    v_permlane32_swap_b32 v16, v17
    v_permlane32_swap_b32 v18, v19
    v_add_f32 v16, v16, v17
    v_add_f32 v18, v18, v19
    v_mul_f32 v16, 0xbb000000, v16
    s_waitcnt lgkmcnt(6)
    v_mfma_f32_32x32x16_bf16 v[112:127], v[24:27], v[136:139], v[112:127]
    ds_read_b128 v[56:59], v5 offset:51200
    v_mul_f32 v18, 0x3b000000, v18
    v_cvt_pk_bf16_f32 v12, v16, v16
    v_cvt_pk_bf16_f32 v13, v16, v16
    v_cvt_pk_bf16_f32 v14, v16, v16
    v_cvt_pk_bf16_f32 v15, v16, v16
    v_mfma_f32_32x32x16_bf16 v[112:127], v[28:31], v[140:143], v[112:127]
    ds_read_b128 v[60:63], v5 offset:24576
    ds_read_b32 v1, v9 offset:272
    v_fma_f32 v18, -v16, v16, v18
    v_max_f32 v18, 0, v18
    v_cvt_pk_bf16_f32 v18, v18, v18
    v_lshlrev_b32 v18, 16, v18
    s_waitcnt lgkmcnt(7)
    v_mfma_f32_32x32x16_bf16 v[112:127], v[32:35], v[144:147], v[112:127]
    ds_read_b128 v[24:27], v5 offset:25600
    v_add_f32 v18, 0x3727c5ac, v18
    v_cvt_pk_bf16_f32 v18, v18, v18
    v_lshlrev_b32 v18, 16, v18
    v_sqrt_f32 v18, v18
    v_mfma_f32_32x32x16_bf16 v[112:127], v[36:39], v[148:151], v[112:127]
    ds_read_b128 v[28:31], v5 offset:26624
    v_cvt_pk_bf16_f32 v18, v18, v18
    v_lshlrev_b32 v18, 16, v18
    v_rcp_f32 v6, v18
    v_mul_f32 v7, v18, v18
    s_waitcnt lgkmcnt(7)
    v_mfma_f32_32x32x16_bf16 v[112:127], v[40:43], v[152:155], v[112:127]
    ds_read_b128 v[32:35], v5 offset:27648
    v_mul_f32 v6, 0xbfb8aa3b, v6
    v_mfma_f32_32x32x16_bf16 v[112:127], v[44:47], v[156:159], v[112:127]
    ds_read_b128 v[36:39], v5 offset:28672
    s_waitcnt lgkmcnt(7)
    v_mfma_f32_32x32x16_bf16 v[64:79], v[48:51], v[12:15], v[64:79]
    ds_read_b128 v[40:43], v5 offset:29696
    v_mfma_f32_32x32x16_bf16 v[80:95], v[52:55], v[12:15], v[80:95]
    ds_read_b128 v[44:47], v5 offset:30720
    s_waitcnt lgkmcnt(7)
    v_mfma_f32_32x32x16_bf16 v[96:111], v[56:59], v[12:15], v[96:111]
    ds_read_b128 v[48:51], v5 offset:31744
    s_nop 5
    v_mul_f32 v16, v64, v6
    v_mul_f32 v17, v65, v6
    v_mul_f32 v18, v66, v6
    v_mul_f32 v19, v67, v6
    v_mul_f32 v20, v68, v6
    v_mfma_f32_32x32x16_bf16 v[112:127], v[60:63], v[160:163], v[112:127]
    s_waitcnt lgkmcnt(7)
    v_cmp_ne_u32 vcc, 0, v1
    s_cbranch_vccnz ff_xs17
ff_xg17:
    ds_read_b128 v[52:55], v5 offset:32768
    v_mul_f32 v21, v69, v6
    v_mul_f32 v22, v70, v6
    v_mul_f32 v23, v71, v6
    v_exp_f32 v16, v16
    s_waitcnt lgkmcnt(6)
    v_mfma_f32_32x32x16_bf16 v[112:127], v[24:27], v[164:167], v[112:127]
    ds_read_b128 v[56:59], v5 offset:33792
    v_mul_f32 v64, v64, v72
    v_exp_f32 v17, v17
    v_mul_f32 v65, v65, v73
    v_mfma_f32_32x32x16_bf16 v[112:127], v[28:31], v[168:171], v[112:127]
    ds_read_b128 v[60:63], v5 offset:34816
    v_exp_f32 v18, v18
    v_mul_f32 v66, v66, v74
    v_exp_f32 v19, v19
    s_waitcnt lgkmcnt(6)
    v_mfma_f32_32x32x16_bf16 v[112:127], v[32:35], v[172:175], v[112:127]
    ds_read_b128 v[24:27], v5 offset:35840
    v_mul_f32 v67, v67, v75
    v_exp_f32 v20, v20
    v_mul_f32 v68, v68, v76
    v_mfma_f32_32x32x16_bf16 v[112:127], v[36:39], v[176:179], v[112:127]
    ds_read_b128 v[28:31], v5 offset:36864
    v_exp_f32 v21, v21
    v_mul_f32 v69, v69, v77
    v_exp_f32 v22, v22
    s_waitcnt lgkmcnt(6)
    v_mfma_f32_32x32x16_bf16 v[112:127], v[40:43], v[180:183], v[112:127]
    ds_read_b128 v[32:35], v5 offset:37888
    v_mul_f32 v70, v70, v78
    v_exp_f32 v23, v23
    v_mul_f32 v71, v71, v79
    v_fma_f32 v16, v16, v7, v7
    v_mfma_f32_32x32x16_bf16 v[112:127], v[44:47], v[184:187], v[112:127]
    ds_read_b128 v[36:39], v5 offset:38912
    v_fma_f32 v17, v17, v7, v7
    v_fma_f32 v18, v18, v7, v7
    v_fma_f32 v19, v19, v7, v7
    v_fma_f32 v20, v20, v7, v7
    v_fma_f32 v21, v21, v7, v7
    s_waitcnt lgkmcnt(6)
    v_mfma_f32_32x32x16_bf16 v[112:127], v[48:51], v[188:191], v[112:127]
    ds_read_b128 v[40:43], v5 offset:39936
    v_fma_f32 v22, v22, v7, v7
    v_fma_f32 v23, v23, v7, v7
    v_rcp_f32 v16, v16
    v_mfma_f32_32x32x16_bf16 v[112:127], v[52:55], v[192:195], v[112:127]
    ds_read_b128 v[44:47], v5 offset:40960
    ds_read_b32 v1, v9 offset:288
    v_rcp_f32 v17, v17
    v_mul_f32 v64, v64, v16
    v_rcp_f32 v18, v18
    s_waitcnt lgkmcnt(7)
    v_mfma_f32_32x32x16_bf16 v[112:127], v[56:59], v[196:199], v[112:127]
    ds_read_b128 v[48:51], v5 offset:41984
    v_mul_f32 v65, v65, v17
    v_rcp_f32 v19, v19
    v_mul_f32 v66, v66, v18
    v_mfma_f32_32x32x16_bf16 v[112:127], v[60:63], v[200:203], v[112:127]
    ds_read_b128 v[52:55], v5 offset:43008
    v_rcp_f32 v20, v20
    v_mul_f32 v67, v67, v19
    v_rcp_f32 v21, v21
    s_waitcnt lgkmcnt(7)
    v_mfma_f32_32x32x16_bf16 v[112:127], v[24:27], v[204:207], v[112:127]
    ds_read_b128 v[56:59], v5 offset:44032
    v_mul_f32 v68, v68, v20
    v_rcp_f32 v22, v22
    v_mul_f32 v69, v69, v21
    v_mfma_f32_32x32x16_bf16 v[112:127], v[28:31], v[208:211], v[112:127]
    ds_read_b128 v[60:63], v5 offset:45056
    v_rcp_f32 v23, v23
    v_mul_f32 v70, v70, v22
    v_cvt_pk_bf16_f32 v72, v64, v65
    v_mul_f32 v71, v71, v23
    s_waitcnt lgkmcnt(7)
    v_mfma_f32_32x32x16_bf16 v[112:127], v[32:35], v[212:215], v[112:127]
    ds_read_b128 v[24:27], v5 offset:46080
    v_cvt_pk_bf16_f32 v73, v66, v67
    v_cvt_pk_bf16_f32 v74, v68, v69
    v_cvt_pk_bf16_f32 v75, v70, v71
    buffer_store_dwordx4 v[72:75], v3, s[16:19], s37 offen offset:0 sc1
    v_mul_f32 v16, v80, v6
    v_mfma_f32_32x32x16_bf16 v[112:127], v[36:39], v[216:219], v[112:127]
    ds_read_b128 v[28:31], v5 offset:47104
    v_mul_f32 v17, v81, v6
    v_mul_f32 v18, v82, v6
    v_mul_f32 v19, v83, v6
    v_mul_f32 v20, v84, v6
    v_mul_f32 v21, v85, v6
    s_waitcnt lgkmcnt(7)
    v_mfma_f32_32x32x16_bf16 v[112:127], v[40:43], v[220:223], v[112:127]
    ds_read_b128 v[32:35], v5 offset:48128
    v_mul_f32 v22, v86, v6
    v_mul_f32 v23, v87, v6
    v_exp_f32 v16, v16
    v_mfma_f32_32x32x16_bf16 v[112:127], v[44:47], v[224:227], v[112:127]
    ds_read_b128 v[36:39], v5 offset:52224
    v_mul_f32 v80, v80, v88
    v_exp_f32 v17, v17
    v_mul_f32 v81, v81, v89
    s_waitcnt lgkmcnt(6)
    v_mfma_f32_32x32x16_bf16 v[112:127], v[48:51], v[228:231], v[112:127]
    v_cmp_ne_u32 vcc, 0, v1
    s_cbranch_vccnz ff_xs18
ff_xg18:
    ds_read_b128 v[40:43], v3 offset:0
    v_exp_f32 v18, v18
    v_mul_f32 v82, v82, v90
    v_exp_f32 v19, v19
    v_mfma_f32_32x32x16_bf16 v[112:127], v[52:55], v[232:235], v[112:127]
    ds_read_b128 v[44:47], v3 offset:1024
    v_mul_f32 v83, v83, v91
    v_exp_f32 v20, v20
    v_mul_f32 v84, v84, v92
    s_waitcnt lgkmcnt(6)
    v_mfma_f32_32x32x16_bf16 v[112:127], v[56:59], v[236:239], v[112:127]
    ds_read_b128 v[48:51], v3 offset:2048
    v_exp_f32 v21, v21
    v_mul_f32 v85, v85, v93
    v_exp_f32 v22, v22
    v_mfma_f32_32x32x16_bf16 v[112:127], v[60:63], v[240:243], v[112:127]
    ds_read_b128 v[52:55], v3 offset:3072
    v_mul_f32 v86, v86, v94
    v_exp_f32 v23, v23
    v_mul_f32 v87, v87, v95
    v_fma_f32 v16, v16, v7, v7
    s_waitcnt lgkmcnt(6)
    v_mfma_f32_32x32x16_bf16 v[112:127], v[24:27], v[244:247], v[112:127]
    ds_read_b128 v[56:59], v3 offset:4096
    v_fma_f32 v17, v17, v7, v7
    v_fma_f32 v18, v18, v7, v7
    v_fma_f32 v19, v19, v7, v7
    v_fma_f32 v20, v20, v7, v7
    v_fma_f32 v21, v21, v7, v7
    v_mfma_f32_32x32x16_bf16 v[112:127], v[28:31], v[248:251], v[112:127]
    ds_read_b128 v[60:63], v3 offset:5120
    v_fma_f32 v22, v22, v7, v7
    v_fma_f32 v23, v23, v7, v7
    v_rcp_f32 v16, v16
    s_waitcnt lgkmcnt(6)
    v_mfma_f32_32x32x16_bf16 v[112:127], v[32:35], v[252:255], v[112:127]
    ds_read_b128 v[24:27], v3 offset:6144
    v_rcp_f32 v17, v17
    v_mul_f32 v80, v80, v16
    v_rcp_f32 v18, v18
    v_mfma_f32_32x32x16_bf16 v[112:127], v[36:39], v[12:15], v[112:127]
    ds_read_b128 v[28:31], v3 offset:7168
    v_mul_f32 v81, v81, v17
    v_rcp_f32 v19, v19
    v_mul_f32 v82, v82, v18
    s_waitcnt lgkmcnt(6)
    v_mfma_f32_32x32x16_bf16 v[64:79], v[40:43], v[128:131], 0
    ds_read_b128 v[32:35], v3 offset:8192
    ds_read_b32 v1, v9 offset:304
    v_rcp_f32 v20, v20
    v_mul_f32 v83, v83, v19
    v_rcp_f32 v21, v21
    v_mfma_f32_32x32x16_bf16 v[64:79], v[44:47], v[132:135], v[64:79]
    ds_read_b128 v[36:39], v3 offset:9216
    v_mul_f32 v84, v84, v20
    v_rcp_f32 v22, v22
    v_mul_f32 v85, v85, v21
    s_waitcnt lgkmcnt(7)
    v_mfma_f32_32x32x16_bf16 v[64:79], v[48:51], v[136:139], v[64:79]
    ds_read_b128 v[40:43], v3 offset:10240
    v_rcp_f32 v23, v23
    v_mul_f32 v86, v86, v22
    v_cvt_pk_bf16_f32 v88, v80, v81
    v_mul_f32 v87, v87, v23
    v_mfma_f32_32x32x16_bf16 v[64:79], v[52:55], v[140:143], v[64:79]
    ds_read_b128 v[44:47], v3 offset:11264
    v_cvt_pk_bf16_f32 v89, v82, v83
    v_cvt_pk_bf16_f32 v90, v84, v85
    v_cvt_pk_bf16_f32 v91, v86, v87
    buffer_store_dwordx4 v[88:91], v3, s[16:19], s37 offen offset:1024 sc1
    v_mul_f32 v16, v96, v6
    s_waitcnt lgkmcnt(7)
    v_mfma_f32_32x32x16_bf16 v[64:79], v[56:59], v[144:147], v[64:79]
    ds_read_b128 v[48:51], v3 offset:12288
    v_mul_f32 v17, v97, v6
    v_mul_f32 v18, v98, v6
    v_mul_f32 v19, v99, v6
    v_mul_f32 v20, v100, v6
    v_mul_f32 v21, v101, v6
    v_mfma_f32_32x32x16_bf16 v[64:79], v[60:63], v[148:151], v[64:79]
    ds_read_b128 v[52:55], v3 offset:13312
    v_mul_f32 v22, v102, v6
    v_mul_f32 v23, v103, v6
    v_exp_f32 v16, v16
    s_waitcnt lgkmcnt(7)
    v_mfma_f32_32x32x16_bf16 v[64:79], v[24:27], v[152:155], v[64:79]
    ds_read_b128 v[56:59], v3 offset:14336
    v_mul_f32 v96, v96, v104
    v_exp_f32 v17, v17
    v_mul_f32 v97, v97, v105
    v_mfma_f32_32x32x16_bf16 v[64:79], v[28:31], v[156:159], v[64:79]
    ds_read_b128 v[60:63], v3 offset:15360
    v_exp_f32 v18, v18
    v_mul_f32 v98, v98, v106
    v_exp_f32 v19, v19
    s_waitcnt lgkmcnt(6)
    v_mfma_f32_32x32x16_bf16 v[64:79], v[32:35], v[160:163], v[64:79]
    v_cmp_ne_u32 vcc, 0, v1
    s_cbranch_vccnz ff_xs19
ff_xg19:
    ds_read_b128 v[24:27], v3 offset:16384
    v_mul_f32 v99, v99, v107
    v_exp_f32 v20, v20
    v_mul_f32 v100, v100, v108
    v_mfma_f32_32x32x16_bf16 v[64:79], v[36:39], v[164:167], v[64:79]
    ds_read_b128 v[28:31], v3 offset:17408
    v_exp_f32 v21, v21
    v_mul_f32 v101, v101, v109
    v_exp_f32 v22, v22
    s_waitcnt lgkmcnt(6)
    v_mfma_f32_32x32x16_bf16 v[64:79], v[40:43], v[168:171], v[64:79]
    ds_read_b128 v[32:35], v3 offset:18432
    v_mul_f32 v102, v102, v110
    v_exp_f32 v23, v23
    v_mul_f32 v103, v103, v111
    v_fma_f32 v16, v16, v7, v7
    v_mfma_f32_32x32x16_bf16 v[64:79], v[44:47], v[172:175], v[64:79]
    ds_read_b128 v[36:39], v3 offset:19456
    v_fma_f32 v17, v17, v7, v7
    v_fma_f32 v18, v18, v7, v7
    v_fma_f32 v19, v19, v7, v7
    v_fma_f32 v20, v20, v7, v7
    v_fma_f32 v21, v21, v7, v7
    s_waitcnt lgkmcnt(6)
    v_mfma_f32_32x32x16_bf16 v[64:79], v[48:51], v[176:179], v[64:79]
    ds_read_b128 v[40:43], v3 offset:20480
    v_fma_f32 v22, v22, v7, v7
    v_fma_f32 v23, v23, v7, v7
    v_rcp_f32 v16, v16
    v_mfma_f32_32x32x16_bf16 v[64:79], v[52:55], v[180:183], v[64:79]
    ds_read_b128 v[44:47], v3 offset:21504
    v_rcp_f32 v17, v17
    v_mul_f32 v96, v96, v16
    v_rcp_f32 v18, v18
    s_waitcnt lgkmcnt(6)
    v_mfma_f32_32x32x16_bf16 v[64:79], v[56:59], v[184:187], v[64:79]
    ds_read_b128 v[48:51], v3 offset:22528
    v_mul_f32 v97, v97, v17
    v_rcp_f32 v19, v19
    v_mul_f32 v98, v98, v18
    v_mfma_f32_32x32x16_bf16 v[64:79], v[60:63], v[188:191], v[64:79]
    ds_read_b128 v[52:55], v3 offset:23552
    v_rcp_f32 v20, v20
    v_mul_f32 v99, v99, v19
    v_rcp_f32 v21, v21
    s_waitcnt lgkmcnt(6)
    v_mfma_f32_32x32x16_bf16 v[64:79], v[24:27], v[192:195], v[64:79]
    ds_read_b128 v[56:59], v3 offset:24576
    ds_read_b32 v1, v9 offset:320
    v_mul_f32 v100, v100, v20
    v_rcp_f32 v22, v22
    v_mul_f32 v101, v101, v21
    v_mfma_f32_32x32x16_bf16 v[64:79], v[28:31], v[196:199], v[64:79]
    ds_read_b128 v[60:63], v3 offset:25600
    v_rcp_f32 v23, v23
    v_mul_f32 v102, v102, v22
    v_cvt_pk_bf16_f32 v104, v96, v97
    v_mul_f32 v103, v103, v23
    s_waitcnt lgkmcnt(7)
    v_mfma_f32_32x32x16_bf16 v[64:79], v[32:35], v[200:203], v[64:79]
    ds_read_b128 v[24:27], v3 offset:26624
    v_cvt_pk_bf16_f32 v105, v98, v99
    v_cvt_pk_bf16_f32 v106, v100, v101
    v_cvt_pk_bf16_f32 v107, v102, v103
    buffer_store_dwordx4 v[104:107], v3, s[16:19], s37 offen offset:2048 sc1
    v_mul_f32 v16, v112, v6
    v_mfma_f32_32x32x16_bf16 v[64:79], v[36:39], v[204:207], v[64:79]
    ds_read_b128 v[28:31], v3 offset:27648
    v_mul_f32 v17, v113, v6
    v_mul_f32 v18, v114, v6
    v_mul_f32 v19, v115, v6
    v_mul_f32 v20, v116, v6
    v_mul_f32 v21, v117, v6
    s_waitcnt lgkmcnt(7)
    v_mfma_f32_32x32x16_bf16 v[64:79], v[40:43], v[208:211], v[64:79]
    ds_read_b128 v[32:35], v3 offset:28672
    v_mul_f32 v22, v118, v6
    v_mul_f32 v23, v119, v6
    v_exp_f32 v16, v16
    v_mfma_f32_32x32x16_bf16 v[64:79], v[44:47], v[212:215], v[64:79]
    ds_read_b128 v[36:39], v3 offset:29696
    v_mul_f32 v112, v112, v120
    v_exp_f32 v17, v17
    v_mul_f32 v113, v113, v121
    s_waitcnt lgkmcnt(7)
    v_mfma_f32_32x32x16_bf16 v[64:79], v[48:51], v[216:219], v[64:79]
    ds_read_b128 v[40:43], v3 offset:30720
    v_exp_f32 v18, v18
    v_mul_f32 v114, v114, v122
    v_exp_f32 v19, v19
    v_mfma_f32_32x32x16_bf16 v[64:79], v[52:55], v[220:223], v[64:79]
    ds_read_b128 v[44:47], v3 offset:31744
    v_mul_f32 v115, v115, v123
    v_exp_f32 v20, v20
    v_mul_f32 v116, v116, v124
    s_waitcnt lgkmcnt(6)
    v_mfma_f32_32x32x16_bf16 v[64:79], v[56:59], v[224:227], v[64:79]
    ds_read_b128 v[48:51], v5 offset:53248
    v_exp_f32 v21, v21
    v_mul_f32 v117, v117, v125
    v_exp_f32 v22, v22
    v_mfma_f32_32x32x16_bf16 v[64:79], v[60:63], v[228:231], v[64:79]
    v_cmp_ne_u32 vcc, 0, v1
    s_cbranch_vccnz ff_xs20
ff_xg20:
    ds_read_b128 v[52:55], v3 offset:32768
    v_mul_f32 v118, v118, v126
    v_exp_f32 v23, v23
    v_mul_f32 v119, v119, v127
    v_fma_f32 v16, v16, v7, v7
    s_waitcnt lgkmcnt(6)
    v_mfma_f32_32x32x16_bf16 v[64:79], v[24:27], v[232:235], v[64:79]
    ds_read_b128 v[56:59], v3 offset:33792
    v_fma_f32 v17, v17, v7, v7
    v_fma_f32 v18, v18, v7, v7
    v_fma_f32 v19, v19, v7, v7
    v_fma_f32 v20, v20, v7, v7
    v_fma_f32 v21, v21, v7, v7
    s_waitcnt vmcnt(1)
    s_mov_b64 exec, 1
    s_add_u32 s39, s38, 0
    buffer_store_dword v10, v11, s[16:19], s39 offen sc1
    s_mov_b64 exec, -1
    v_mfma_f32_32x32x16_bf16 v[64:79], v[28:31], v[236:239], v[64:79]
    ds_read_b128 v[60:63], v3 offset:34816
    v_fma_f32 v22, v22, v7, v7
    v_fma_f32 v23, v23, v7, v7
    v_rcp_f32 v16, v16
    s_waitcnt lgkmcnt(6)
    v_mfma_f32_32x32x16_bf16 v[64:79], v[32:35], v[240:243], v[64:79]
    ds_read_b128 v[24:27], v3 offset:35840
    v_rcp_f32 v17, v17
    v_mul_f32 v112, v112, v16
    v_rcp_f32 v18, v18
    v_mfma_f32_32x32x16_bf16 v[64:79], v[36:39], v[244:247], v[64:79]
    ds_read_b128 v[28:31], v3 offset:36864
    v_mul_f32 v113, v113, v17
    v_rcp_f32 v19, v19
    v_mul_f32 v114, v114, v18
    s_waitcnt lgkmcnt(6)
    v_mfma_f32_32x32x16_bf16 v[64:79], v[40:43], v[248:251], v[64:79]
    ds_read_b128 v[32:35], v3 offset:37888
    v_rcp_f32 v20, v20
    v_mul_f32 v115, v115, v19
    v_rcp_f32 v21, v21
    v_mfma_f32_32x32x16_bf16 v[64:79], v[44:47], v[252:255], v[64:79]
    ds_read_b128 v[36:39], v3 offset:38912
    v_mul_f32 v116, v116, v20
    v_rcp_f32 v22, v22
    v_mul_f32 v117, v117, v21
    s_waitcnt lgkmcnt(6)
    v_mfma_f32_32x32x16_bf16 v[64:79], v[48:51], v[12:15], v[64:79]
    ds_read_b128 v[40:43], v3 offset:39936
    v_rcp_f32 v23, v23
    v_mul_f32 v118, v118, v22
    v_cvt_pk_bf16_f32 v120, v112, v113
    v_mul_f32 v119, v119, v23
    v_mfma_f32_32x32x16_bf16 v[80:95], v[52:55], v[128:131], 0
    ds_read_b128 v[44:47], v3 offset:40960
    ds_read_b32 v1, v9 offset:336
    v_cvt_pk_bf16_f32 v121, v114, v115
    v_cvt_pk_bf16_f32 v122, v116, v117
    v_cvt_pk_bf16_f32 v123, v118, v119
    buffer_store_dwordx4 v[120:123], v3, s[16:19], s37 offen offset:3072 sc1
    s_waitcnt lgkmcnt(7)
    v_mfma_f32_32x32x16_bf16 v[80:95], v[56:59], v[132:135], v[80:95]
    s_barrier
    ds_read_b128 v[48:51], v3 offset:41984
    v_mul_f32 v16, v64, v6
    v_mul_f32 v17, v65, v6
    v_mul_f32 v18, v66, v6
    v_mul_f32 v19, v67, v6
    v_mul_f32 v20, v68, v6
    v_mfma_f32_32x32x16_bf16 v[80:95], v[60:63], v[136:139], v[80:95]
    ds_read_b128 v[52:55], v3 offset:43008
    v_mul_f32 v21, v69, v6
    v_mul_f32 v22, v70, v6
    v_mul_f32 v23, v71, v6
    v_exp_f32 v16, v16
    s_waitcnt lgkmcnt(7)
    v_mfma_f32_32x32x16_bf16 v[80:95], v[24:27], v[140:143], v[80:95]
    ds_read_b128 v[56:59], v3 offset:44032
    v_mul_f32 v64, v64, v72
    v_exp_f32 v17, v17
    v_mul_f32 v65, v65, v73
    v_mfma_f32_32x32x16_bf16 v[80:95], v[28:31], v[144:147], v[80:95]
    ds_read_b128 v[60:63], v3 offset:45056
    v_exp_f32 v18, v18
    v_mul_f32 v66, v66, v74
    v_exp_f32 v19, v19
    s_waitcnt lgkmcnt(7)
    v_mfma_f32_32x32x16_bf16 v[80:95], v[32:35], v[148:151], v[80:95]
    ds_read_b128 v[24:27], v3 offset:46080
    v_mul_f32 v67, v67, v75
    v_exp_f32 v20, v20
    v_mul_f32 v68, v68, v76
    v_mfma_f32_32x32x16_bf16 v[80:95], v[36:39], v[152:155], v[80:95]
    ds_read_b128 v[28:31], v3 offset:47104
    v_exp_f32 v21, v21
    v_mul_f32 v69, v69, v77
    v_exp_f32 v22, v22
    s_waitcnt lgkmcnt(7)
    v_mfma_f32_32x32x16_bf16 v[80:95], v[40:43], v[156:159], v[80:95]
    ds_read_b128 v[32:35], v3 offset:48128
    v_mul_f32 v70, v70, v78
    v_exp_f32 v23, v23
    v_mul_f32 v71, v71, v79
    v_fma_f32 v16, v16, v7, v7
    v_mfma_f32_32x32x16_bf16 v[80:95], v[44:47], v[160:163], v[80:95]
    s_waitcnt lgkmcnt(7)
    v_cmp_ne_u32 vcc, 0, v1
    s_cbranch_vccnz ff_xs21
ff_xg21:
    ds_read_b128 v[36:39], v4 offset:0
    v_fma_f32 v17, v17, v7, v7
    v_fma_f32 v18, v18, v7, v7
    v_fma_f32 v19, v19, v7, v7
    v_fma_f32 v20, v20, v7, v7
    v_fma_f32 v21, v21, v7, v7
    s_waitcnt lgkmcnt(6)
    v_mfma_f32_32x32x16_bf16 v[80:95], v[48:51], v[164:167], v[80:95]
    ds_read_b128 v[40:43], v4 offset:1024
    v_fma_f32 v22, v22, v7, v7
    v_fma_f32 v23, v23, v7, v7
    v_rcp_f32 v16, v16
    v_mfma_f32_32x32x16_bf16 v[80:95], v[52:55], v[168:171], v[80:95]
    ds_read_b128 v[44:47], v4 offset:2048
    v_rcp_f32 v17, v17
    v_mul_f32 v64, v64, v16
    v_rcp_f32 v18, v18
    s_waitcnt lgkmcnt(6)
    v_mfma_f32_32x32x16_bf16 v[80:95], v[56:59], v[172:175], v[80:95]
    ds_read_b128 v[48:51], v4 offset:3072
    v_mul_f32 v65, v65, v17
    v_rcp_f32 v19, v19
    v_mul_f32 v66, v66, v18
    v_mfma_f32_32x32x16_bf16 v[80:95], v[60:63], v[176:179], v[80:95]
    ds_read_b128 v[52:55], v4 offset:4096
    v_rcp_f32 v20, v20
    v_mul_f32 v67, v67, v19
    v_rcp_f32 v21, v21
    s_waitcnt lgkmcnt(6)
    v_mfma_f32_32x32x16_bf16 v[80:95], v[24:27], v[180:183], v[80:95]
    ds_read_b128 v[56:59], v4 offset:5120
    v_mul_f32 v68, v68, v20
    v_rcp_f32 v22, v22
    v_mul_f32 v69, v69, v21
    v_mfma_f32_32x32x16_bf16 v[80:95], v[28:31], v[184:187], v[80:95]
    ds_read_b128 v[60:63], v4 offset:6144
    v_rcp_f32 v23, v23
    v_mul_f32 v70, v70, v22
    v_cvt_pk_bf16_f32 v72, v64, v65
    v_mul_f32 v71, v71, v23
    s_waitcnt lgkmcnt(6)
    v_mfma_f32_32x32x16_bf16 v[80:95], v[32:35], v[188:191], v[80:95]
    ds_read_b128 v[24:27], v4 offset:7168
    v_cvt_pk_bf16_f32 v73, v66, v67
    v_cvt_pk_bf16_f32 v74, v68, v69
    v_cvt_pk_bf16_f32 v75, v70, v71
    buffer_store_dwordx4 v[72:75], v3, s[16:19], s36 offen offset:0 sc1
    v_mfma_f32_32x32x16_bf16 v[80:95], v[36:39], v[192:195], v[80:95]
    ds_read_b128 v[28:31], v4 offset:8192
    ds_read_b32 v1, v9 offset:352
    s_waitcnt lgkmcnt(7)
    v_mfma_f32_32x32x16_bf16 v[80:95], v[40:43], v[196:199], v[80:95]
    ds_read_b128 v[32:35], v4 offset:9216
    v_mfma_f32_32x32x16_bf16 v[80:95], v[44:47], v[200:203], v[80:95]
    ds_read_b128 v[36:39], v4 offset:10240
    s_waitcnt lgkmcnt(7)
    v_mfma_f32_32x32x16_bf16 v[80:95], v[48:51], v[204:207], v[80:95]
    ds_read_b128 v[40:43], v4 offset:11264
    v_mfma_f32_32x32x16_bf16 v[80:95], v[52:55], v[208:211], v[80:95]
    ds_read_b128 v[44:47], v4 offset:12288
    s_waitcnt lgkmcnt(7)
    v_mfma_f32_32x32x16_bf16 v[80:95], v[56:59], v[212:215], v[80:95]
    ds_read_b128 v[48:51], v4 offset:13312
    v_mfma_f32_32x32x16_bf16 v[80:95], v[60:63], v[216:219], v[80:95]
    ds_read_b128 v[52:55], v4 offset:14336
    s_waitcnt lgkmcnt(7)
    v_mfma_f32_32x32x16_bf16 v[80:95], v[24:27], v[220:223], v[80:95]
    ds_read_b128 v[56:59], v4 offset:15360
    v_mfma_f32_32x32x16_bf16 v[80:95], v[28:31], v[224:227], v[80:95]
    ds_read_b128 v[60:63], v5 offset:54272
    s_waitcnt lgkmcnt(6)
    v_mfma_f32_32x32x16_bf16 v[80:95], v[32:35], v[228:231], v[80:95]
    v_cmp_ne_u32 vcc, 0, v1
    s_cbranch_vccnz ff_xs22
ff_xg22:
    ds_read_b128 v[24:27], v4 offset:16384
    v_mfma_f32_32x32x16_bf16 v[80:95], v[36:39], v[232:235], v[80:95]
    ds_read_b128 v[28:31], v4 offset:17408
    s_waitcnt lgkmcnt(6)
    v_mfma_f32_32x32x16_bf16 v[80:95], v[40:43], v[236:239], v[80:95]
    ds_read_b128 v[32:35], v4 offset:18432
    v_mfma_f32_32x32x16_bf16 v[80:95], v[44:47], v[240:243], v[80:95]
    ds_read_b128 v[36:39], v4 offset:19456
    s_waitcnt lgkmcnt(6)
    v_mfma_f32_32x32x16_bf16 v[80:95], v[48:51], v[244:247], v[80:95]
    ds_read_b128 v[40:43], v4 offset:20480
    v_mfma_f32_32x32x16_bf16 v[80:95], v[52:55], v[248:251], v[80:95]
    ds_read_b128 v[44:47], v4 offset:21504
    s_waitcnt lgkmcnt(6)
    v_mfma_f32_32x32x16_bf16 v[80:95], v[56:59], v[252:255], v[80:95]
    ds_read_b128 v[48:51], v4 offset:22528
    v_mfma_f32_32x32x16_bf16 v[80:95], v[60:63], v[12:15], v[80:95]
    ds_read_b128 v[52:55], v4 offset:23552
    s_waitcnt lgkmcnt(6)
    v_mfma_f32_32x32x16_bf16 v[96:111], v[24:27], v[128:131], 0
    ds_read_b128 v[56:59], v4 offset:24576
    ds_read_b32 v1, v9 offset:368
    v_mfma_f32_32x32x16_bf16 v[96:111], v[28:31], v[132:135], v[96:111]
    ds_read_b128 v[60:63], v4 offset:25600
    s_nop 4
    v_mul_f32 v16, v80, v6
    v_mul_f32 v17, v81, v6
    v_mul_f32 v18, v82, v6
    v_mul_f32 v19, v83, v6
    v_mul_f32 v20, v84, v6
    s_waitcnt lgkmcnt(7)
    v_mfma_f32_32x32x16_bf16 v[96:111], v[32:35], v[136:139], v[96:111]
    ds_read_b128 v[24:27], v4 offset:26624
    v_mul_f32 v21, v85, v6
    v_mul_f32 v22, v86, v6
    v_mul_f32 v23, v87, v6
    v_exp_f32 v16, v16
    v_mfma_f32_32x32x16_bf16 v[96:111], v[36:39], v[140:143], v[96:111]
    ds_read_b128 v[28:31], v4 offset:27648
    v_mul_f32 v80, v80, v88
    v_exp_f32 v17, v17
    v_mul_f32 v81, v81, v89
    s_waitcnt lgkmcnt(7)
    v_mfma_f32_32x32x16_bf16 v[96:111], v[40:43], v[144:147], v[96:111]
    ds_read_b128 v[32:35], v4 offset:28672
    v_exp_f32 v18, v18
    v_mul_f32 v82, v82, v90
    v_exp_f32 v19, v19
    v_mfma_f32_32x32x16_bf16 v[96:111], v[44:47], v[148:151], v[96:111]
    ds_read_b128 v[36:39], v4 offset:29696
    v_mul_f32 v83, v83, v91
    v_exp_f32 v20, v20
    v_mul_f32 v84, v84, v92
    s_waitcnt lgkmcnt(7)
    v_mfma_f32_32x32x16_bf16 v[96:111], v[48:51], v[152:155], v[96:111]
    ds_read_b128 v[40:43], v4 offset:30720
    v_exp_f32 v21, v21
    v_mul_f32 v85, v85, v93
    v_exp_f32 v22, v22
    s_waitcnt vmcnt(0)
    s_mov_b64 exec, 1
    s_add_u32 s39, s38, 16384
    buffer_store_dword v10, v11, s[16:19], s39 offen sc1
    s_mov_b64 exec, -1
    v_mfma_f32_32x32x16_bf16 v[96:111], v[52:55], v[156:159], v[96:111]
    ds_read_b128 v[44:47], v4 offset:31744
    v_mul_f32 v86, v86, v94
    v_exp_f32 v23, v23
    v_mul_f32 v87, v87, v95
    v_fma_f32 v16, v16, v7, v7
    s_waitcnt lgkmcnt(6)
    v_mfma_f32_32x32x16_bf16 v[96:111], v[56:59], v[160:163], v[96:111]
    v_cmp_ne_u32 vcc, 0, v1
    s_cbranch_vccnz ff_xs23
ff_xg23:
    ds_read_b128 v[48:51], v4 offset:32768
    v_fma_f32 v17, v17, v7, v7
    v_fma_f32 v18, v18, v7, v7
    v_fma_f32 v19, v19, v7, v7
    v_fma_f32 v20, v20, v7, v7
    v_fma_f32 v21, v21, v7, v7
    v_mfma_f32_32x32x16_bf16 v[96:111], v[60:63], v[164:167], v[96:111]
    ds_read_b128 v[52:55], v4 offset:33792
    v_fma_f32 v22, v22, v7, v7
    v_fma_f32 v23, v23, v7, v7
    v_rcp_f32 v16, v16
    s_waitcnt lgkmcnt(6)
    v_mfma_f32_32x32x16_bf16 v[96:111], v[24:27], v[168:171], v[96:111]
    ds_read_b128 v[56:59], v4 offset:34816
    v_rcp_f32 v17, v17
    v_mul_f32 v80, v80, v16
    v_rcp_f32 v18, v18
    v_mfma_f32_32x32x16_bf16 v[96:111], v[28:31], v[172:175], v[96:111]
    ds_read_b128 v[60:63], v4 offset:35840
    v_mul_f32 v81, v81, v17
    v_rcp_f32 v19, v19
    v_mul_f32 v82, v82, v18
    s_waitcnt lgkmcnt(6)
    v_mfma_f32_32x32x16_bf16 v[96:111], v[32:35], v[176:179], v[96:111]
    ds_read_b128 v[24:27], v4 offset:36864
    v_rcp_f32 v20, v20
    v_mul_f32 v83, v83, v19
    v_rcp_f32 v21, v21
    v_mfma_f32_32x32x16_bf16 v[96:111], v[36:39], v[180:183], v[96:111]
    ds_read_b128 v[28:31], v4 offset:37888
    v_mul_f32 v84, v84, v20
    v_rcp_f32 v22, v22
    v_mul_f32 v85, v85, v21
    s_waitcnt lgkmcnt(6)
    v_mfma_f32_32x32x16_bf16 v[96:111], v[40:43], v[184:187], v[96:111]
    ds_read_b128 v[32:35], v4 offset:38912
    v_rcp_f32 v23, v23
    v_mul_f32 v86, v86, v22
    v_cvt_pk_bf16_f32 v88, v80, v81
    v_mul_f32 v87, v87, v23
    v_mfma_f32_32x32x16_bf16 v[96:111], v[44:47], v[188:191], v[96:111]
    ds_read_b128 v[36:39], v4 offset:39936
    v_cvt_pk_bf16_f32 v89, v82, v83
    v_cvt_pk_bf16_f32 v90, v84, v85
    v_cvt_pk_bf16_f32 v91, v86, v87
    buffer_store_dwordx4 v[88:91], v3, s[16:19], s36 offen offset:1024 sc1
    s_waitcnt lgkmcnt(6)
    v_mfma_f32_32x32x16_bf16 v[96:111], v[48:51], v[192:195], v[96:111]
    ds_read_b128 v[40:43], v4 offset:40960
    v_mfma_f32_32x32x16_bf16 v[96:111], v[52:55], v[196:199], v[96:111]
    ds_read_b128 v[44:47], v4 offset:41984
    s_waitcnt lgkmcnt(6)
    v_mfma_f32_32x32x16_bf16 v[96:111], v[56:59], v[200:203], v[96:111]
    ds_read_b128 v[48:51], v4 offset:43008
    v_mfma_f32_32x32x16_bf16 v[96:111], v[60:63], v[204:207], v[96:111]
    ds_read_b128 v[52:55], v4 offset:44032
    s_waitcnt lgkmcnt(6)
    v_mfma_f32_32x32x16_bf16 v[96:111], v[24:27], v[208:211], v[96:111]
    ds_read_b128 v[56:59], v4 offset:45056
    v_mfma_f32_32x32x16_bf16 v[96:111], v[28:31], v[212:215], v[96:111]
    ds_read_b128 v[60:63], v4 offset:46080
    s_waitcnt lgkmcnt(6)
    v_mfma_f32_32x32x16_bf16 v[96:111], v[32:35], v[216:219], v[96:111]
    ds_read_b128 v[24:27], v4 offset:47104
    v_mfma_f32_32x32x16_bf16 v[96:111], v[36:39], v[220:223], v[96:111]
    ds_read_b128 v[28:31], v4 offset:48128
    s_waitcnt lgkmcnt(6)
    v_mfma_f32_32x32x16_bf16 v[96:111], v[40:43], v[224:227], v[96:111]
    ds_read_b128 v[32:35], v5 offset:55296
    v_mfma_f32_32x32x16_bf16 v[96:111], v[44:47], v[228:231], v[96:111]
    s_waitcnt lgkmcnt(5)
    v_mfma_f32_32x32x16_bf16 v[96:111], v[48:51], v[232:235], v[96:111]
    v_mfma_f32_32x32x16_bf16 v[96:111], v[52:55], v[236:239], v[96:111]
    s_waitcnt lgkmcnt(3)
    v_mfma_f32_32x32x16_bf16 v[96:111], v[56:59], v[240:243], v[96:111]
    v_mfma_f32_32x32x16_bf16 v[96:111], v[60:63], v[244:247], v[96:111]
    s_waitcnt lgkmcnt(1)
    v_mfma_f32_32x32x16_bf16 v[96:111], v[24:27], v[248:251], v[96:111]
    v_mfma_f32_32x32x16_bf16 v[96:111], v[28:31], v[252:255], v[96:111]
    s_waitcnt lgkmcnt(0)
    v_mfma_f32_32x32x16_bf16 v[96:111], v[32:35], v[12:15], v[96:111]
    s_nop 11
    v_mul_f32 v16, v96, v6
    v_mul_f32 v17, v97, v6
    v_mul_f32 v18, v98, v6
    v_mul_f32 v19, v99, v6
    v_mul_f32 v20, v100, v6
    v_mul_f32 v21, v101, v6
    v_mul_f32 v22, v102, v6
    v_mul_f32 v23, v103, v6
    v_exp_f32 v16, v16
    v_mul_f32 v96, v96, v104
    v_exp_f32 v17, v17
    v_mul_f32 v97, v97, v105
    v_exp_f32 v18, v18
    v_mul_f32 v98, v98, v106
    v_exp_f32 v19, v19
    v_mul_f32 v99, v99, v107
    v_exp_f32 v20, v20
    v_mul_f32 v100, v100, v108
    v_exp_f32 v21, v21
    v_mul_f32 v101, v101, v109
    v_exp_f32 v22, v22
    v_mul_f32 v102, v102, v110
    v_exp_f32 v23, v23
    v_mul_f32 v103, v103, v111
    v_fma_f32 v16, v16, v7, v7
    v_fma_f32 v17, v17, v7, v7
    v_fma_f32 v18, v18, v7, v7
    v_fma_f32 v19, v19, v7, v7
    v_fma_f32 v20, v20, v7, v7
    v_fma_f32 v21, v21, v7, v7
    v_fma_f32 v22, v22, v7, v7
    v_fma_f32 v23, v23, v7, v7
    v_rcp_f32 v16, v16
    v_rcp_f32 v17, v17
    v_mul_f32 v96, v96, v16
    v_rcp_f32 v18, v18
    v_mul_f32 v97, v97, v17
    v_rcp_f32 v19, v19
    v_mul_f32 v98, v98, v18
    v_rcp_f32 v20, v20
    v_mul_f32 v99, v99, v19
    v_rcp_f32 v21, v21
    v_mul_f32 v100, v100, v20
    v_rcp_f32 v22, v22
    v_mul_f32 v101, v101, v21
    v_rcp_f32 v23, v23
    v_mul_f32 v102, v102, v22
    v_cvt_pk_bf16_f32 v104, v96, v97
    v_mul_f32 v103, v103, v23
    v_cvt_pk_bf16_f32 v105, v98, v99
    v_cvt_pk_bf16_f32 v106, v100, v101
    v_cvt_pk_bf16_f32 v107, v102, v103
    buffer_store_dwordx4 v[104:107], v3, s[16:19], s36 offen offset:2048 sc1
    s_mov_b64 exec, 1
    s_waitcnt vmcnt(1)
    s_add_u32 s39, s38, 32768
    buffer_store_dword v10, v11, s[16:19], s39 offen sc1
    s_waitcnt vmcnt(1)
    s_add_u32 s39, s38, 49152
    buffer_store_dword v10, v11, s[16:19], s39 offen sc1
    s_endpgm
ff_xs1:
sp_11:
    ds_read_b32 v1, v9 offset:16
    s_add_u32 s44, s44, 1
    s_cmp_gt_u32 s44, 0x100000
    s_cbranch_scc1 spd_12
    s_waitcnt lgkmcnt(0)
    v_cmp_ne_u32 vcc, 0, v1
    s_cbranch_vccnz sp_11
spd_12:
    s_branch ff_xg1
ff_xs2:
sp_13:
    ds_read_b32 v1, v9 offset:32
    s_add_u32 s44, s44, 1
    s_cmp_gt_u32 s44, 0x100000
    s_cbranch_scc1 spd_14
    s_waitcnt lgkmcnt(0)
    v_cmp_ne_u32 vcc, 0, v1
    s_cbranch_vccnz sp_13
spd_14:
    s_branch ff_xg2
ff_xs3:
sp_15:
    ds_read_b32 v1, v9 offset:48
    s_add_u32 s44, s44, 1
    s_cmp_gt_u32 s44, 0x100000
    s_cbranch_scc1 spd_16
    s_waitcnt lgkmcnt(0)
    v_cmp_ne_u32 vcc, 0, v1
    s_cbranch_vccnz sp_15
spd_16:
    s_branch ff_xg3
ff_xs4:
sp_17:
    ds_read_b32 v1, v9 offset:64
    s_add_u32 s44, s44, 1
    s_cmp_gt_u32 s44, 0x100000
    s_cbranch_scc1 spd_18
    s_waitcnt lgkmcnt(0)
    v_cmp_ne_u32 vcc, 0, v1
    s_cbranch_vccnz sp_17
spd_18:
    s_branch ff_xg4
ff_xs5:
sp_19:
    ds_read_b32 v1, v9 offset:80
    s_add_u32 s44, s44, 1
    s_cmp_gt_u32 s44, 0x100000
    s_cbranch_scc1 spd_20
    s_waitcnt lgkmcnt(0)
    v_cmp_ne_u32 vcc, 0, v1
    s_cbranch_vccnz sp_19
spd_20:
    s_branch ff_xg5
ff_xs6:
sp_21:
    ds_read_b32 v1, v9 offset:96
    s_add_u32 s44, s44, 1
    s_cmp_gt_u32 s44, 0x100000
    s_cbranch_scc1 spd_22
    s_waitcnt lgkmcnt(0)
    v_cmp_ne_u32 vcc, 0, v1
    s_cbranch_vccnz sp_21
spd_22:
    s_branch ff_xg6
ff_xs7:
sp_23:
    ds_read_b32 v1, v9 offset:112
    s_add_u32 s44, s44, 1
    s_cmp_gt_u32 s44, 0x100000
    s_cbranch_scc1 spd_24
    s_waitcnt lgkmcnt(0)
    v_cmp_ne_u32 vcc, 0, v1
    s_cbranch_vccnz sp_23
spd_24:
    s_branch ff_xg7
ff_xs8:
sp_25:
    ds_read_b32 v1, v9 offset:128
    s_add_u32 s44, s44, 1
    s_cmp_gt_u32 s44, 0x100000
    s_cbranch_scc1 spd_26
    s_waitcnt lgkmcnt(0)
    v_cmp_ne_u32 vcc, 0, v1
    s_cbranch_vccnz sp_25
spd_26:
    s_branch ff_xg8
ff_xs9:
sp_27:
    ds_read_b32 v1, v9 offset:144
    s_add_u32 s44, s44, 1
    s_cmp_gt_u32 s44, 0x100000
    s_cbranch_scc1 spd_28
    s_waitcnt lgkmcnt(0)
    v_cmp_ne_u32 vcc, 0, v1
    s_cbranch_vccnz sp_27
spd_28:
    s_branch ff_xg9
ff_xs10:
sp_29:
    ds_read_b32 v1, v9 offset:160
    s_add_u32 s44, s44, 1
    s_cmp_gt_u32 s44, 0x100000
    s_cbranch_scc1 spd_30
    s_waitcnt lgkmcnt(0)
    v_cmp_ne_u32 vcc, 0, v1
    s_cbranch_vccnz sp_29
spd_30:
    s_branch ff_xg10
ff_xs11:
sp_31:
    ds_read_b32 v1, v9 offset:176
    s_add_u32 s44, s44, 1
    s_cmp_gt_u32 s44, 0x100000
    s_cbranch_scc1 spd_32
    s_waitcnt lgkmcnt(0)
    v_cmp_ne_u32 vcc, 0, v1
    s_cbranch_vccnz sp_31
spd_32:
    s_branch ff_xg11
ff_xs12:
sp_33:
    ds_read_b32 v1, v9 offset:192
    s_add_u32 s44, s44, 1
    s_cmp_gt_u32 s44, 0x100000
    s_cbranch_scc1 spd_34
    s_waitcnt lgkmcnt(0)
    v_cmp_ne_u32 vcc, 0, v1
    s_cbranch_vccnz sp_33
spd_34:
    s_branch ff_xg12
ff_xs13:
sp_35:
    ds_read_b32 v1, v9 offset:208
    s_add_u32 s44, s44, 1
    s_cmp_gt_u32 s44, 0x100000
    s_cbranch_scc1 spd_36
    s_waitcnt lgkmcnt(0)
    v_cmp_ne_u32 vcc, 0, v1
    s_cbranch_vccnz sp_35
spd_36:
    s_branch ff_xg13
ff_xs14:
sp_37:
    ds_read_b32 v1, v9 offset:224
    s_add_u32 s44, s44, 1
    s_cmp_gt_u32 s44, 0x100000
    s_cbranch_scc1 spd_38
    s_waitcnt lgkmcnt(0)
    v_cmp_ne_u32 vcc, 0, v1
    s_cbranch_vccnz sp_37
spd_38:
    s_branch ff_xg14
ff_xs15:
sp_39:
    ds_read_b32 v1, v9 offset:240
    s_add_u32 s44, s44, 1
    s_cmp_gt_u32 s44, 0x100000
    s_cbranch_scc1 spd_40
    s_waitcnt lgkmcnt(0)
    v_cmp_ne_u32 vcc, 0, v1
    s_cbranch_vccnz sp_39
spd_40:
    s_branch ff_xg15
ff_xs16:
sp_41:
    ds_read_b32 v1, v9 offset:256
    s_add_u32 s44, s44, 1
    s_cmp_gt_u32 s44, 0x100000
    s_cbranch_scc1 spd_42
    s_waitcnt lgkmcnt(0)
    v_cmp_ne_u32 vcc, 0, v1
    s_cbranch_vccnz sp_41
spd_42:
    s_branch ff_xg16
ff_xs17:
sp_43:
    ds_read_b32 v1, v9 offset:272
    s_add_u32 s44, s44, 1
    s_cmp_gt_u32 s44, 0x100000
    s_cbranch_scc1 spd_44
    s_waitcnt lgkmcnt(0)
    v_cmp_ne_u32 vcc, 0, v1
    s_cbranch_vccnz sp_43
spd_44:
    s_branch ff_xg17
ff_xs18:
sp_45:
    ds_read_b32 v1, v9 offset:288
    s_add_u32 s44, s44, 1
    s_cmp_gt_u32 s44, 0x100000
    s_cbranch_scc1 spd_46
    s_waitcnt lgkmcnt(0)
    v_cmp_ne_u32 vcc, 0, v1
    s_cbranch_vccnz sp_45
spd_46:
    s_branch ff_xg18
ff_xs19:
sp_47:
    ds_read_b32 v1, v9 offset:304
    s_add_u32 s44, s44, 1
    s_cmp_gt_u32 s44, 0x100000
    s_cbranch_scc1 spd_48
    s_waitcnt lgkmcnt(0)
    v_cmp_ne_u32 vcc, 0, v1
    s_cbranch_vccnz sp_47
spd_48:
    s_branch ff_xg19
ff_xs20:
sp_49:
    ds_read_b32 v1, v9 offset:320
    s_add_u32 s44, s44, 1
    s_cmp_gt_u32 s44, 0x100000
    s_cbranch_scc1 spd_50
    s_waitcnt lgkmcnt(0)
    v_cmp_ne_u32 vcc, 0, v1
    s_cbranch_vccnz sp_49
spd_50:
    s_branch ff_xg20
ff_xs21:
sp_51:
    ds_read_b32 v1, v9 offset:336
    s_add_u32 s44, s44, 1
    s_cmp_gt_u32 s44, 0x100000
    s_cbranch_scc1 spd_52
    s_waitcnt lgkmcnt(0)
    v_cmp_ne_u32 vcc, 0, v1
    s_cbranch_vccnz sp_51
spd_52:
    s_branch ff_xg21
ff_xs22:
sp_53:
    ds_read_b32 v1, v9 offset:352
    s_add_u32 s44, s44, 1
    s_cmp_gt_u32 s44, 0x100000
    s_cbranch_scc1 spd_54
    s_waitcnt lgkmcnt(0)
    v_cmp_ne_u32 vcc, 0, v1
    s_cbranch_vccnz sp_53
spd_54:
    s_branch ff_xg22
ff_xs23:
sp_55:
    ds_read_b32 v1, v9 offset:368
    s_add_u32 s44, s44, 1
    s_cmp_gt_u32 s44, 0x100000
    s_cbranch_scc1 spd_56
    s_waitcnt lgkmcnt(0)
    v_cmp_ne_u32 vcc, 0, v1
    s_cbranch_vccnz sp_55
spd_56:
    s_branch ff_xg23
ff_ld:
    s_mul_i32 s28, s22, 237568
    s_lshl_b32 s25, s21, 17
    s_lshl_b32 s26, s20, 11
    v_add_u32 v16, s26, v3
    s_lshr_b32 s30, s20, 1
    s_mul_i32 s30, s30, 7168
    s_and_b32 s24, s20, 1
    s_mul_i32 s24, s24, 1536
    s_add_u32 s30, s30, s24
    s_mul_i32 s27, s20, 1536
    s_mov_b32 s31, 0
    s_lshl_b32 s24, s20, 12
    s_mul_i32 s32, s20, 28672
    s_lshl_b32 s29, s20, 2
    s_add_u32 s29, s29, 162816
    s_mov_b32 s47, 0x7f000000
    s_add_u32 m0, s26, 8192
    s_waitcnt lgkmcnt(0)
    s_add_u32 s12, s4, 0x426000
    s_addc_u32 s13, s5, 0
    s_add_u32 s12, s12, s25
    s_addc_u32 s13, s13, 0
    s_mov_b32 s14, 0x20000
    s_mov_b32 s15, 0x20000
    s_add_u32 s8, s4, 0x626000
    s_addc_u32 s9, s5, 0
    s_add_u32 s8, s8, s28
    s_addc_u32 s9, s9, 0
    s_mov_b32 s10, 0x39c00
    s_mov_b32 s11, 0x20000
    s_waitcnt vmcnt(20)
    buffer_load_dwordx4 v16, s[12:15], s31 offen lds
    buffer_load_dwordx4 v16, s[12:15], s31 offen offset:1024 lds
    s_add_u32 m0, s27, 0
    s_add_u32 s31, s31, 8192
    s_waitcnt vmcnt(20)
    buffer_load_dwordx4 v3, s[8:11], s30 offen lds
    s_mov_b32 exec_hi, 0
    buffer_load_dwordx4 v3, s[8:11], s30 offen offset:1024 lds
    s_add_u32 s30, s30, 14336
    s_barrier
    s_add_u32 m0, s29, 0
    s_mov_b64 exec, 1
    buffer_load_dword v3, s[8:11], s47 offen lds
    s_mov_b64 exec, -1
    s_add_u32 m0, s26, 24576
    s_waitcnt vmcnt(20)
    buffer_load_dwordx4 v16, s[12:15], s31 offen lds
    buffer_load_dwordx4 v16, s[12:15], s31 offen offset:1024 lds
    s_add_u32 m0, s27, 16384
    s_add_u32 s31, s31, 8192
    s_waitcnt vmcnt(20)
    buffer_load_dwordx4 v3, s[8:11], s30 offen lds
    s_mov_b32 exec_hi, 0
    buffer_load_dwordx4 v3, s[8:11], s30 offen offset:1024 lds
    s_add_u32 s30, s30, 14336
    s_add_u32 m0, s29, 16
    s_mov_b64 exec, 1
    buffer_load_dword v3, s[8:11], s47 offen lds
    s_mov_b64 exec, -1
    s_and_b32 s48, s2, 7
    s_lshl_b32 s48, s48, 2
    s_bfe_u32 s49, s2, 0x20003
    s_add_u32 s48, s48, s49
    s_lshr_b32 s49, s2, 5
    s_mul_i32 s50, s48, 224
    s_mul_i32 s52, s20, 28
    s_add_u32 s50, s50, s52
    s_lshl_b32 s50, s50, 10
    s_add_u32 s50, s50, 12083200
    s_mul_i32 s51, s49, 112
    s_add_u32 s51, s51, s52
    s_lshl_b32 s51, s51, 11
    s_add_u32 s51, s51, 10248192
    s_and_b32 s53, s49, 0
    s_xor_b32 s54, s53, 0
    s_mul_i32 s54, s54, 7168
    s_add_u32 s68, s50, s54
    s_lshl_b32 s54, s54, 1
    s_add_u32 s72, s51, s54
    s_xor_b32 s54, s53, 1
    s_mul_i32 s54, s54, 7168
    s_add_u32 s69, s50, s54
    s_lshl_b32 s54, s54, 1
    s_add_u32 s73, s51, s54
    s_xor_b32 s54, s53, 2
    s_mul_i32 s54, s54, 7168
    s_add_u32 s70, s50, s54
    s_lshl_b32 s54, s54, 1
    s_add_u32 s74, s51, s54
    s_xor_b32 s54, s53, 3
    s_mul_i32 s54, s54, 7168
    s_add_u32 s71, s50, s54
    s_lshl_b32 s54, s54, 1
    s_add_u32 s75, s51, s54
    s_lshr_b32 s56, s20, 1
    s_and_b32 s57, s20, 1
    s_lshl_b32 s58, s56, 10
    v_add_u32 v8, s58, v3
    v_xor_b32 v9, 0x400, v8
    s_mul_i32 s58, s57, 0x1c000
    v_add_u32 v10, s58, v3
    v_xor_b32 v11, 0x1c000, v10
    s_mov_b32 s16, s4
    s_mov_b32 s17, s5
    s_mov_b32 s18, 0x1286000
    s_mov_b32 s19, 0x20000
    s_mov_b32 s40, s6
    s_mov_b32 s41, s7
    s_mov_b32 s42, 0x200000
    s_mov_b32 s43, 0x20000
    s_add_u32 m0, s26, 40960
    s_waitcnt vmcnt(20)
    buffer_load_dwordx4 v16, s[12:15], s31 offen lds
    buffer_load_dwordx4 v16, s[12:15], s31 offen offset:1024 lds
    s_add_u32 m0, s27, 32768
    s_add_u32 s31, s31, 8192
    s_waitcnt vmcnt(20)
    buffer_load_dwordx4 v3, s[8:11], s30 offen lds
    s_mov_b32 exec_hi, 0
    buffer_load_dwordx4 v3, s[8:11], s30 offen offset:1024 lds
    s_add_u32 s30, s30, 14336
    s_add_u32 m0, s29, 32
    s_mov_b64 exec, 1
    buffer_load_dword v3, s[8:11], s47 offen lds
    s_mov_b64 exec, -1
    s_add_u32 m0, s26, 57344
    s_waitcnt vmcnt(20)
    buffer_load_dwordx4 v16, s[12:15], s31 offen lds
    buffer_load_dwordx4 v16, s[12:15], s31 offen offset:1024 lds
    s_add_u32 m0, s27, 49152
    s_add_u32 s31, s31, 8192
    s_waitcnt vmcnt(20)
    buffer_load_dwordx4 v3, s[8:11], s30 offen lds
    s_mov_b32 exec_hi, 0
    buffer_load_dwordx4 v3, s[8:11], s30 offen offset:1024 lds
    s_add_u32 s30, s30, 14336
    s_add_u32 m0, s29, 48
    s_mov_b64 exec, 1
    buffer_load_dword v3, s[8:11], s47 offen lds
    s_mov_b64 exec, -1
    s_mul_i32 s58, s20, 12288
    s_add_u32 s58, s58, 98304
    v_add_u32 v12, s58, v3
    s_lshl_b32 s77, s20, 13
    s_sub_u32 s78, s77, s58
    v_lshrrev_b32 v5, 3, v2
    v_and_b32 v6, 7, v2
    s_and_b32 s59, s48, 1
    s_lshl_b32 s59, s59, 3
    v_or_b32 v6, s59, v6
    v_and_b32 v7, 3, v5
    v_lshlrev_b32 v7, 2, v7
    v_xor_b32 v6, v6, v7
    v_lshlrev_b32 v5, 8, v5
    v_lshl_add_u32 v5, v6, 4, v5
    s_lshl_b32 s59, s49, 14
    s_lshl_b32 s60, s20, 12
    s_add_u32 s59, s59, s60
    s_lshr_b32 s60, s48, 1
    s_lshl_b32 s60, s60, 17
    s_add_u32 s59, s59, s60
    s_add_u32 s59, s59, 4349952
    s_add_u32 s60, s59, 0x800
    s_lshl_b32 s61, s57, 11
    s_lshl_b32 s64, s56, 12
    s_add_u32 s61, s61, s64
    v_mov_b32 v17, v5
    s_mov_b32 s66, s59
    s_mov_b32 s67, s60
    s_add_u32 s76, s61, 154624
    v_and_b32 v4, 15, v2
    v_lshrrev_b32 v5, 4, v2
    v_lshrrev_b32 v6, 2, v4
    v_and_b32 v7, 3, v4
    v_lshrrev_b32 v13, 1, v5
    v_and_b32 v5, 1, v5
    v_lshl_add_u32 v14, v13, 2, v6
    v_lshlrev_b32 v14, 7, v14
    v_lshl_add_u32 v14, v5, 5, v14
    v_lshl_add_u32 v14, v7, 3, v14
    s_lshl_b32 s60, s57, 6
    s_add_u32 s59, s64, s60
    s_add_u32 s59, s59, 154624
    v_add_u32 v14, s59, v14
    v_and_b32 v15, 31, v2
    v_lshlrev_b32 v15, 10, v15
    v_lshl_add_u32 v15, v13, 4, v15
    s_lshl_b32 s62, s48, 16
    s_lshl_b32 s60, s57, 15
    s_add_u32 s62, s62, s60
    s_lshl_b32 s60, s49, 7
    s_add_u32 s62, s62, s60
    s_lshl_b32 s60, s56, 6
    s_add_u32 s62, s62, s60
    s_mov_b32 s63, 0xffff0000
    s_lshl_b32 s59, s48, 2
    s_add_u32 s59, s59, s20
    s_lshl_b32 s59, s59, 7
    s_add_u32 s59, s59, 4284416
    v_and_b32 v13, 7, v2
    v_lshlrev_b32 v13, 2, v13
    s_mov_b32 s60, 0
    s_xor_b32 s33, s20, 1
    s_mul_i32 s33, s33, 12288
    v_add_u32 v4, s33, v3
    s_xor_b32 s33, s20, 2
    s_mul_i32 s33, s33, 12288
    v_add_u32 v5, s33, v3
    s_xor_b32 s33, s20, 3
    s_mul_i32 s33, s33, 12288
    v_add_u32 v6, s33, v3
    s_mul_i32 s33, s20, 12288
    v_add_u32 v7, s33, v3
    s_add_u32 m0, s26, 73728
    s_waitcnt vmcnt(20)
    buffer_load_dwordx4 v16, s[12:15], s31 offen lds
    buffer_load_dwordx4 v16, s[12:15], s31 offen offset:1024 lds
    s_add_u32 m0, s27, 65536
    s_add_u32 s31, s31, 8192
    s_waitcnt vmcnt(20)
    buffer_load_dwordx4 v3, s[8:11], s30 offen lds
    s_mov_b32 exec_hi, 0
    buffer_load_dwordx4 v3, s[8:11], s30 offen offset:1024 lds
    s_add_u32 s30, s30, 14336
    s_add_u32 m0, s29, 64
    s_mov_b64 exec, 1
    buffer_load_dword v3, s[8:11], s47 offen lds
    s_mov_b64 exec, -1
    s_add_u32 m0, s26, 90112
    s_waitcnt vmcnt(20)
    buffer_load_dwordx4 v16, s[12:15], s31 offen lds
    buffer_load_dwordx4 v16, s[12:15], s31 offen offset:1024 lds
    s_add_u32 m0, s27, 81920
    s_add_u32 s31, s31, 8192
    s_waitcnt vmcnt(20)
    buffer_load_dwordx4 v3, s[8:11], s30 offen lds
    s_mov_b32 exec_hi, 0
    buffer_load_dwordx4 v3, s[8:11], s30 offen offset:1024 lds
    s_add_u32 s30, s30, 14336
    s_add_u32 m0, s29, 80
    s_mov_b64 exec, 1
    buffer_load_dword v3, s[8:11], s47 offen lds
    s_mov_b64 exec, -1
    s_add_u32 s55, s72, 0
    s_waitcnt vmcnt(20)
    buffer_load_dwordx4 v[112:115], v8, s[16:19], s55 offen
    s_waitcnt vmcnt(20)
    buffer_load_dwordx4 v[116:119], v9, s[16:19], s55 offen
    s_add_u32 m0, s26, 106496
    s_waitcnt vmcnt(20)
    buffer_load_dwordx4 v16, s[12:15], s31 offen lds
    buffer_load_dwordx4 v16, s[12:15], s31 offen offset:1024 lds
    s_add_u32 m0, s27, 98304
    s_add_u32 s31, s31, 8192
    s_waitcnt vmcnt(20)
    buffer_load_dwordx4 v3, s[8:11], s30 offen lds
    s_mov_b32 exec_hi, 0
    buffer_load_dwordx4 v3, s[8:11], s30 offen offset:1024 lds
    s_add_u32 s30, s30, 14336
    s_add_u32 m0, s29, 96
    s_mov_b64 exec, 1
    buffer_load_dword v3, s[8:11], s47 offen lds
    s_mov_b64 exec, -1
    s_add_u32 s55, s72, 2048
    s_waitcnt vmcnt(20)
    buffer_load_dwordx4 v[120:123], v8, s[16:19], s55 offen
    s_waitcnt vmcnt(20)
    buffer_load_dwordx4 v[124:127], v9, s[16:19], s55 offen
    s_add_u32 m0, s26, 122880
    s_waitcnt vmcnt(20)
    buffer_load_dwordx4 v16, s[12:15], s31 offen lds
    buffer_load_dwordx4 v16, s[12:15], s31 offen offset:1024 lds
    s_add_u32 m0, s27, 114688
    s_add_u32 s31, s31, 8192
    s_waitcnt vmcnt(20)
    buffer_load_dwordx4 v3, s[8:11], s30 offen lds
    s_mov_b32 exec_hi, 0
    buffer_load_dwordx4 v3, s[8:11], s30 offen offset:1024 lds
    s_add_u32 s30, s30, 14336
    s_add_u32 m0, s29, 112
    s_mov_b64 exec, 1
    buffer_load_dword v3, s[8:11], s47 offen lds
    s_mov_b64 exec, -1
    s_add_u32 s55, s73, 0
    s_waitcnt vmcnt(20)
    buffer_load_dwordx4 v[128:131], v8, s[16:19], s55 offen
    s_waitcnt vmcnt(20)
    buffer_load_dwordx4 v[132:135], v9, s[16:19], s55 offen
    s_add_u32 m0, s26, 139264
    s_waitcnt vmcnt(20)
    buffer_load_dwordx4 v16, s[12:15], s31 offen lds
    buffer_load_dwordx4 v16, s[12:15], s31 offen offset:1024 lds
    s_add_u32 m0, s27, 131072
    s_add_u32 s31, s31, 8192
    s_waitcnt vmcnt(20)
    buffer_load_dwordx4 v3, s[8:11], s30 offen lds
    s_mov_b32 exec_hi, 0
    buffer_load_dwordx4 v3, s[8:11], s30 offen offset:1024 lds
    s_add_u32 s30, s30, 14336
    s_add_u32 m0, s29, 128
    s_mov_b64 exec, 1
    buffer_load_dword v3, s[8:11], s47 offen lds
    s_mov_b64 exec, -1
    s_add_u32 s55, s73, 2048
    s_waitcnt vmcnt(20)
    buffer_load_dwordx4 v[136:139], v8, s[16:19], s55 offen
    s_waitcnt vmcnt(20)
    buffer_load_dwordx4 v[140:143], v9, s[16:19], s55 offen
    s_barrier
    s_add_u32 m0, s26, 8192
    s_waitcnt vmcnt(20)
    buffer_load_dwordx4 v16, s[12:15], s31 offen lds
    buffer_load_dwordx4 v16, s[12:15], s31 offen offset:1024 lds
    s_add_u32 m0, s27, 0
    s_add_u32 s31, s31, 8192
    s_waitcnt vmcnt(20)
    buffer_load_dwordx4 v3, s[8:11], s30 offen lds
    s_mov_b32 exec_hi, 0
    buffer_load_dwordx4 v3, s[8:11], s30 offen offset:1024 lds
    s_add_u32 s30, s30, 14336
    s_add_u32 m0, s29, 144
    s_mov_b64 exec, 1
    buffer_load_dword v3, s[8:11], s47 offen lds
    s_mov_b64 exec, -1
    s_add_u32 m0, s26, 24576
    s_waitcnt vmcnt(20)
    buffer_load_dwordx4 v16, s[12:15], s31 offen lds
    buffer_load_dwordx4 v16, s[12:15], s31 offen offset:1024 lds
    s_add_u32 m0, s27, 16384
    s_add_u32 s31, s31, 8192
    s_waitcnt vmcnt(20)
    buffer_load_dwordx4 v3, s[8:11], s30 offen lds
    s_mov_b32 exec_hi, 0
    buffer_load_dwordx4 v3, s[8:11], s30 offen offset:1024 lds
    s_add_u32 s30, s30, 14336
    s_add_u32 m0, s29, 160
    s_mov_b64 exec, 1
    buffer_load_dword v3, s[8:11], s47 offen lds
    s_mov_b64 exec, -1
    s_add_u32 m0, s26, 40960
    s_waitcnt vmcnt(20)
    buffer_load_dwordx4 v16, s[12:15], s31 offen lds
    buffer_load_dwordx4 v16, s[12:15], s31 offen offset:1024 lds
    s_add_u32 m0, s27, 32768
    s_add_u32 s31, s31, 8192
    s_waitcnt vmcnt(20)
    buffer_load_dwordx4 v3, s[8:11], s30 offen lds
    s_mov_b32 exec_hi, 0
    buffer_load_dwordx4 v3, s[8:11], s30 offen offset:1024 lds
    s_mov_b32 exec_hi, -1
    s_add_u32 s30, s30, 14336
    s_add_u32 m0, s26, 147456
    s_mov_b32 s33, 229376
    s_waitcnt vmcnt(20)
    buffer_load_dwordx4 v16, s[8:11], s33 offen lds
    buffer_load_dwordx4 v16, s[8:11], s33 offen offset:1024 lds
    s_add_u32 m0, s29, 176
    s_mov_b64 exec, 1
    buffer_load_dword v3, s[8:11], s47 offen lds
    s_mov_b64 exec, -1
    s_add_u32 m0, s26, 57344
    s_waitcnt vmcnt(20)
    buffer_load_dwordx4 v16, s[12:15], s31 offen lds
    buffer_load_dwordx4 v16, s[12:15], s31 offen offset:1024 lds
    s_add_u32 m0, s27, 49152
    s_add_u32 s31, s31, 8192
    s_waitcnt vmcnt(20)
    buffer_load_dwordx4 v3, s[8:11], s30 offen lds
    s_mov_b32 exec_hi, 0
    buffer_load_dwordx4 v3, s[8:11], s30 offen offset:1024 lds
    s_add_u32 s30, s30, 14336
    s_add_u32 m0, s29, 192
    s_mov_b64 exec, 1
    buffer_load_dword v3, s[8:11], s47 offen lds
    s_mov_b64 exec, -1
    s_barrier
    s_add_u32 m0, s26, 73728
    s_waitcnt vmcnt(20)
    buffer_load_dwordx4 v16, s[12:15], s31 offen lds
    buffer_load_dwordx4 v16, s[12:15], s31 offen offset:1024 lds
    s_add_u32 m0, s27, 65536
    s_add_u32 s31, s31, 8192
    s_waitcnt vmcnt(20)
    buffer_load_dwordx4 v3, s[8:11], s30 offen lds
    s_mov_b32 exec_hi, 0
    buffer_load_dwordx4 v3, s[8:11], s30 offen offset:1024 lds
    s_add_u32 s30, s30, 14336
    s_add_u32 m0, s29, 208
    s_mov_b64 exec, 1
    buffer_load_dword v3, s[8:11], s47 offen lds
    s_mov_b64 exec, -1
    s_add_u32 m0, s26, 90112
    s_waitcnt vmcnt(20)
    buffer_load_dwordx4 v16, s[12:15], s31 offen lds
    buffer_load_dwordx4 v16, s[12:15], s31 offen offset:1024 lds
    s_add_u32 m0, s27, 81920
    s_add_u32 s31, s31, 8192
    s_waitcnt vmcnt(20)
    buffer_load_dwordx4 v3, s[8:11], s30 offen lds
    s_mov_b32 exec_hi, 0
    buffer_load_dwordx4 v3, s[8:11], s30 offen offset:1024 lds
    s_add_u32 s30, s30, 14336
    s_add_u32 m0, s29, 224
    s_mov_b64 exec, 1
    buffer_load_dword v3, s[8:11], s47 offen lds
    s_mov_b64 exec, -1
    s_add_u32 m0, s26, 106496
    s_waitcnt vmcnt(20)
    buffer_load_dwordx4 v16, s[12:15], s31 offen lds
    buffer_load_dwordx4 v16, s[12:15], s31 offen offset:1024 lds
    s_add_u32 m0, s27, 98304
    s_add_u32 s31, s31, 8192
    s_waitcnt vmcnt(20)
    buffer_load_dwordx4 v3, s[8:11], s30 offen lds
    s_mov_b32 exec_hi, 0
    buffer_load_dwordx4 v3, s[8:11], s30 offen offset:1024 lds
    s_add_u32 s30, s30, 14336
    s_add_u32 m0, s29, 240
    s_mov_b64 exec, 1
    buffer_load_dword v3, s[8:11], s47 offen lds
    s_mov_b64 exec, -1
    s_add_u32 m0, s24, 114688
    s_add_u32 s30, s32, 3072
    s_waitcnt vmcnt(20)
    buffer_load_dwordx4 v3, s[8:11], s30 offen offset:0 lds
    s_add_u32 s30, s32, 9216
    buffer_load_dwordx4 v3, s[8:11], s30 offen offset:1024 lds
    s_add_u32 s30, s32, 15360
    s_waitcnt vmcnt(20)
    buffer_load_dwordx4 v3, s[8:11], s30 offen offset:2048 lds
    s_add_u32 s30, s32, 21504
    buffer_load_dwordx4 v3, s[8:11], s30 offen offset:3072 lds
    s_add_u32 m0, s29, 256
    s_mov_b64 exec, 1
    buffer_load_dword v3, s[8:11], s47 offen lds
    s_mov_b64 exec, -1
    s_barrier
    s_add_u32 m0, s24, 131072
    s_add_u32 s30, s32, 117760
    s_waitcnt vmcnt(20)
    buffer_load_dwordx4 v3, s[8:11], s30 offen offset:0 lds
    s_add_u32 s30, s32, 123904
    buffer_load_dwordx4 v3, s[8:11], s30 offen offset:1024 lds
    s_add_u32 s30, s32, 130048
    s_waitcnt vmcnt(20)
    buffer_load_dwordx4 v3, s[8:11], s30 offen offset:2048 lds
    s_add_u32 s30, s32, 136192
    buffer_load_dwordx4 v3, s[8:11], s30 offen offset:3072 lds
    s_add_u32 m0, s29, 272
    s_mov_b64 exec, 1
    buffer_load_dword v3, s[8:11], s47 offen lds
    s_mov_b64 exec, -1
    s_mov_b32 m0, s76
    s_waitcnt vmcnt(20)
    buffer_load_dwordx4 v17, s[16:19], s66 offen lds
    s_add_u32 m0, m0, 1024
    s_nop 0
    buffer_load_dwordx4 v17, s[16:19], s67 offen lds
    s_add_u32 m0, s24, 0
    s_add_u32 s30, s32, 4096
    s_waitcnt vmcnt(20)
    buffer_load_dwordx4 v3, s[8:11], s30 offen offset:0 lds
    s_add_u32 s30, s32, 10240
    buffer_load_dwordx4 v3, s[8:11], s30 offen offset:1024 lds
    s_add_u32 s30, s32, 16384
    s_waitcnt vmcnt(20)
    buffer_load_dwordx4 v3, s[8:11], s30 offen offset:2048 lds
    s_add_u32 s30, s32, 22528
    buffer_load_dwordx4 v3, s[8:11], s30 offen offset:3072 lds
    s_add_u32 m0, s29, 288
    s_mov_b64 exec, 1
    buffer_load_dword v3, s[8:11], s47 offen lds
    s_mov_b64 exec, -1
    s_barrier
    s_add_u32 m0, s24, 16384
    s_add_u32 s30, s32, 118784
    s_waitcnt vmcnt(20)
    buffer_load_dwordx4 v3, s[8:11], s30 offen offset:0 lds
    s_add_u32 s30, s32, 124928
    buffer_load_dwordx4 v3, s[8:11], s30 offen offset:1024 lds
    s_add_u32 s30, s32, 131072
    s_waitcnt vmcnt(20)
    buffer_load_dwordx4 v3, s[8:11], s30 offen offset:2048 lds
    s_add_u32 s30, s32, 137216
    buffer_load_dwordx4 v3, s[8:11], s30 offen offset:3072 lds
    s_add_u32 m0, s29, 304
    s_mov_b64 exec, 1
    buffer_load_dword v3, s[8:11], s47 offen lds
    s_mov_b64 exec, -1
    s_add_u32 m0, s24, 32768
    s_add_u32 s30, s32, 5120
    s_waitcnt vmcnt(20)
    buffer_load_dwordx4 v3, s[8:11], s30 offen offset:0 lds
    s_add_u32 s30, s32, 11264
    buffer_load_dwordx4 v3, s[8:11], s30 offen offset:1024 lds
    s_add_u32 s30, s32, 17408
    s_waitcnt vmcnt(20)
    buffer_load_dwordx4 v3, s[8:11], s30 offen offset:2048 lds
    s_add_u32 s30, s32, 23552
    buffer_load_dwordx4 v3, s[8:11], s30 offen offset:3072 lds
    s_add_u32 m0, s29, 320
    s_mov_b64 exec, 1
    buffer_load_dword v3, s[8:11], s47 offen lds
    s_mov_b64 exec, -1
    s_barrier
    s_add_u32 m0, s24, 49152
    s_add_u32 s30, s32, 119808
    s_waitcnt vmcnt(20)
    buffer_load_dwordx4 v3, s[8:11], s30 offen offset:0 lds
    s_add_u32 s30, s32, 125952
    buffer_load_dwordx4 v3, s[8:11], s30 offen offset:1024 lds
    s_add_u32 s30, s32, 132096
    s_waitcnt vmcnt(20)
    buffer_load_dwordx4 v3, s[8:11], s30 offen offset:2048 lds
    s_add_u32 s30, s32, 138240
    buffer_load_dwordx4 v3, s[8:11], s30 offen offset:3072 lds
    s_add_u32 m0, s29, 336
    s_mov_b64 exec, 1
    buffer_load_dword v3, s[8:11], s47 offen lds
    s_mov_b64 exec, -1
    s_add_u32 m0, s24, 65536
    s_add_u32 s30, s32, 6144
    s_waitcnt vmcnt(20)
    buffer_load_dwordx4 v3, s[8:11], s30 offen offset:0 lds
    s_add_u32 s30, s32, 12288
    buffer_load_dwordx4 v3, s[8:11], s30 offen offset:1024 lds
    s_add_u32 s30, s32, 18432
    s_waitcnt vmcnt(20)
    buffer_load_dwordx4 v3, s[8:11], s30 offen offset:2048 lds
    s_add_u32 s30, s32, 24576
    buffer_load_dwordx4 v3, s[8:11], s30 offen offset:3072 lds
    s_add_u32 m0, s29, 352
    s_mov_b64 exec, 1
    buffer_load_dword v3, s[8:11], s47 offen lds
    s_mov_b64 exec, -1
    s_add_u32 m0, s24, 81920
    s_add_u32 s30, s32, 120832
    s_waitcnt vmcnt(20)
    buffer_load_dwordx4 v3, s[8:11], s30 offen offset:0 lds
    s_add_u32 s30, s32, 126976
    buffer_load_dwordx4 v3, s[8:11], s30 offen offset:1024 lds
    s_add_u32 s30, s32, 133120
    s_waitcnt vmcnt(20)
    buffer_load_dwordx4 v3, s[8:11], s30 offen offset:2048 lds
    s_add_u32 s30, s32, 139264
    buffer_load_dwordx4 v3, s[8:11], s30 offen offset:3072 lds
    s_add_u32 m0, s29, 368
    s_mov_b64 exec, 1
    buffer_load_dword v3, s[8:11], s47 offen lds
    s_mov_b64 exec, -1
    s_add_u32 s55, s74, 0
    s_waitcnt vmcnt(40)
    buffer_load_dwordx4 v[144:147], v8, s[16:19], s55 offen
    s_waitcnt vmcnt(40)
    buffer_load_dwordx4 v[148:151], v9, s[16:19], s55 offen
    s_add_u32 s55, s74, 2048
    s_waitcnt vmcnt(40)
    buffer_load_dwordx4 v[152:155], v8, s[16:19], s55 offen
    s_waitcnt vmcnt(40)
    buffer_load_dwordx4 v[156:159], v9, s[16:19], s55 offen
    s_add_u32 s55, s75, 0
    s_waitcnt vmcnt(40)
    buffer_load_dwordx4 v[160:163], v8, s[16:19], s55 offen
    s_waitcnt vmcnt(40)
    buffer_load_dwordx4 v[164:167], v9, s[16:19], s55 offen
    s_add_u32 s55, s75, 2048
    s_waitcnt vmcnt(40)
    buffer_load_dwordx4 v[168:171], v8, s[16:19], s55 offen
    s_waitcnt vmcnt(40)
    buffer_load_dwordx4 v[172:175], v9, s[16:19], s55 offen
    s_add_u32 s55, s72, 4096
    s_waitcnt vmcnt(40)
    buffer_load_dwordx4 v[176:179], v8, s[16:19], s55 offen
    s_waitcnt vmcnt(40)
    buffer_load_dwordx4 v[180:183], v9, s[16:19], s55 offen
    s_add_u32 s55, s72, 6144
    s_waitcnt vmcnt(40)
    buffer_load_dwordx4 v[184:187], v8, s[16:19], s55 offen
    s_waitcnt vmcnt(40)
    buffer_load_dwordx4 v[188:191], v9, s[16:19], s55 offen
    s_add_u32 s55, s72, 8192
    s_waitcnt vmcnt(40)
    buffer_load_dwordx4 v[192:195], v8, s[16:19], s55 offen
    s_waitcnt vmcnt(40)
    buffer_load_dwordx4 v[196:199], v9, s[16:19], s55 offen
    s_add_u32 s55, s73, 4096
    s_waitcnt vmcnt(40)
    buffer_load_dwordx4 v[200:203], v8, s[16:19], s55 offen
    s_waitcnt vmcnt(40)
    buffer_load_dwordx4 v[204:207], v9, s[16:19], s55 offen
    s_add_u32 s55, s73, 6144
    s_waitcnt vmcnt(40)
    buffer_load_dwordx4 v[208:211], v8, s[16:19], s55 offen
    s_waitcnt vmcnt(40)
    buffer_load_dwordx4 v[212:215], v9, s[16:19], s55 offen
    s_add_u32 s55, s73, 8192
    s_waitcnt vmcnt(40)
    buffer_load_dwordx4 v[216:219], v8, s[16:19], s55 offen
    s_waitcnt vmcnt(40)
    buffer_load_dwordx4 v[220:223], v9, s[16:19], s55 offen
    s_add_u32 s55, s74, 4096
    s_waitcnt vmcnt(40)
    buffer_load_dwordx4 v[224:227], v8, s[16:19], s55 offen
    s_waitcnt vmcnt(40)
    buffer_load_dwordx4 v[228:231], v9, s[16:19], s55 offen
    s_add_u32 s55, s74, 6144
    s_waitcnt vmcnt(40)
    buffer_load_dwordx4 v[232:235], v8, s[16:19], s55 offen
    s_waitcnt vmcnt(40)
    buffer_load_dwordx4 v[236:239], v9, s[16:19], s55 offen
    s_barrier
    s_add_u32 s55, s74, 8192
    s_waitcnt vmcnt(40)
    buffer_load_dwordx4 v[240:243], v8, s[16:19], s55 offen
    s_waitcnt vmcnt(40)
    buffer_load_dwordx4 v[244:247], v9, s[16:19], s55 offen
    s_add_u32 s55, s75, 4096
    s_waitcnt vmcnt(40)
    buffer_load_dwordx4 v[248:251], v8, s[16:19], s55 offen
    s_waitcnt vmcnt(40)
    buffer_load_dwordx4 v[252:255], v9, s[16:19], s55 offen
    s_mov_b32 m0, s58
    s_add_u32 s55, s75, 6144
    s_waitcnt vmcnt(40)
    buffer_load_dwordx4 v8, s[16:19], s55 offen lds
    s_add_u32 m0, m0, 1024
    s_waitcnt vmcnt(40)
    buffer_load_dwordx4 v9, s[16:19], s55 offen lds
    s_add_u32 m0, m0, 1024
    s_add_u32 s55, s75, 8192
    s_waitcnt vmcnt(40)
    buffer_load_dwordx4 v8, s[16:19], s55 offen lds
    s_add_u32 m0, m0, 1024
    s_waitcnt vmcnt(40)
    buffer_load_dwordx4 v9, s[16:19], s55 offen lds
    s_add_u32 m0, m0, 1024
    s_add_u32 s55, s72, 10240
    s_waitcnt vmcnt(40)
    buffer_load_dwordx4 v8, s[16:19], s55 offen lds
    s_add_u32 m0, m0, 1024
    s_waitcnt vmcnt(40)
    buffer_load_dwordx4 v9, s[16:19], s55 offen lds
    s_add_u32 m0, m0, 1024
    s_add_u32 s55, s73, 10240
    s_waitcnt vmcnt(40)
    buffer_load_dwordx4 v8, s[16:19], s55 offen lds
    s_add_u32 m0, m0, 1024
    s_waitcnt vmcnt(40)
    buffer_load_dwordx4 v9, s[16:19], s55 offen lds
    s_add_u32 m0, m0, 1024
    s_add_u32 s55, s74, 10240
    s_waitcnt vmcnt(40)
    buffer_load_dwordx4 v8, s[16:19], s55 offen lds
    s_add_u32 m0, m0, 1024
    s_waitcnt vmcnt(40)
    buffer_load_dwordx4 v9, s[16:19], s55 offen lds
    s_add_u32 m0, m0, 1024
    s_add_u32 s65, s59, 0
    buffer_load_dword v2, v13, s[16:19], s65 offen sc1
    s_add_u32 s55, s75, 10240
    s_waitcnt vmcnt(40)
    buffer_load_dwordx4 v8, s[16:19], s55 offen lds
    s_add_u32 m0, m0, 1024
    s_waitcnt vmcnt(40)
    buffer_load_dwordx4 v9, s[16:19], s55 offen lds
    s_mov_b32 m0, s77
    s_add_u32 s55, s72, 12288
    s_waitcnt vmcnt(40)
    buffer_load_dwordx4 v8, s[16:19], s55 offen lds
    s_add_u32 m0, m0, 1024
    s_waitcnt vmcnt(40)
    buffer_load_dwordx4 v9, s[16:19], s55 offen lds
    s_add_u32 m0, m0, 1024
    s_add_u32 s55, s73, 12288
    s_waitcnt vmcnt(40)
    buffer_load_dwordx4 v8, s[16:19], s55 offen lds
    s_add_u32 m0, m0, 1024
    s_waitcnt vmcnt(40)
    buffer_load_dwordx4 v9, s[16:19], s55 offen lds
    s_add_u32 m0, m0, 1024
    s_add_u32 s55, s74, 12288
    s_waitcnt vmcnt(40)
    buffer_load_dwordx4 v8, s[16:19], s55 offen lds
    s_add_u32 m0, m0, 1024
    s_waitcnt vmcnt(40)
    buffer_load_dwordx4 v9, s[16:19], s55 offen lds
    s_add_u32 m0, m0, 1024
    s_add_u32 s55, s75, 12288
    s_waitcnt vmcnt(40)
    buffer_load_dwordx4 v8, s[16:19], s55 offen lds
    s_add_u32 m0, m0, 1024
    s_waitcnt vmcnt(40)
    buffer_load_dwordx4 v9, s[16:19], s55 offen lds
    s_add_u32 m0, m0, 1024
    s_waitcnt vmcnt(10)
    v_cmp_eq_u32 vcc, 0, v2
    s_cbranch_vccnz ff_poll0
ff_rdy0:
    s_add_u32 s61, s68, 0
    buffer_load_dwordx4 v[80:83], v10, s[16:19], s61 offen sc1
    buffer_load_dwordx4 v[84:87], v11, s[16:19], s61 offen sc1
    s_add_u32 s61, s68, 1024
    buffer_load_dwordx4 v[88:91], v10, s[16:19], s61 offen sc1
    buffer_load_dwordx4 v[92:95], v11, s[16:19], s61 offen sc1
    s_add_u32 s61, s69, 0
    buffer_load_dwordx4 v[96:99], v10, s[16:19], s61 offen sc1
    buffer_load_dwordx4 v[100:103], v11, s[16:19], s61 offen sc1
    s_add_u32 s61, s69, 1024
    buffer_load_dwordx4 v[104:107], v10, s[16:19], s61 offen sc1
    buffer_load_dwordx4 v[108:111], v11, s[16:19], s61 offen sc1
    s_waitcnt vmcnt(6)
    v_mfma_f32_32x32x16_bf16 v[64:79], v[116:119], v[84:87], 0
    v_mfma_f32_32x32x16_bf16 v[48:63], v[116:119], v[80:83], 0
    v_mfma_f32_32x32x16_bf16 v[32:47], v[112:115], v[84:87], 0
    v_mfma_f32_32x32x16_bf16 v[16:31], v[112:115], v[80:83], 0
    s_add_u32 s65, s59, 16384
    buffer_load_dword v2, v13, s[16:19], s65 offen sc1
    s_add_u32 s61, s70, 0
    buffer_load_dwordx4 v[112:115], v10, s[16:19], s61 offen sc1
    buffer_load_dwordx4 v[116:119], v11, s[16:19], s61 offen sc1
    s_add_u32 s61, s70, 1024
    buffer_load_dwordx4 v[80:83], v10, s[16:19], s61 offen sc1
    buffer_load_dwordx4 v[84:87], v11, s[16:19], s61 offen sc1
    s_waitcnt vmcnt(9)
    v_mfma_f32_32x32x16_bf16 v[64:79], v[124:127], v[92:95], v[64:79]
    v_mfma_f32_32x32x16_bf16 v[48:63], v[124:127], v[88:91], v[48:63]
    v_mfma_f32_32x32x16_bf16 v[32:47], v[120:123], v[92:95], v[32:47]
    v_mfma_f32_32x32x16_bf16 v[16:31], v[120:123], v[88:91], v[16:31]
    s_add_u32 s61, s71, 0
    buffer_load_dwordx4 v[120:123], v10, s[16:19], s61 offen sc1
    buffer_load_dwordx4 v[124:127], v11, s[16:19], s61 offen sc1
    s_add_u32 s61, s71, 1024
    buffer_load_dwordx4 v[88:91], v10, s[16:19], s61 offen sc1
    buffer_load_dwordx4 v[92:95], v11, s[16:19], s61 offen sc1
    s_waitcnt vmcnt(11)
    v_mfma_f32_32x32x16_bf16 v[64:79], v[132:135], v[100:103], v[64:79]
    v_mfma_f32_32x32x16_bf16 v[48:63], v[132:135], v[96:99], v[48:63]
    v_mfma_f32_32x32x16_bf16 v[32:47], v[128:131], v[100:103], v[32:47]
    v_mfma_f32_32x32x16_bf16 v[16:31], v[128:131], v[96:99], v[16:31]
    s_waitcnt vmcnt(8)
    v_cmp_eq_u32 vcc, 0, v2
    s_cbranch_vccnz ff_poll1
ff_rdy1:
    s_add_u32 s61, s68, 2048
    buffer_load_dwordx4 v[128:131], v10, s[16:19], s61 offen sc1
    buffer_load_dwordx4 v[132:135], v11, s[16:19], s61 offen sc1
    s_add_u32 s61, s68, 3072
    buffer_load_dwordx4 v[96:99], v10, s[16:19], s61 offen sc1
    buffer_load_dwordx4 v[100:103], v11, s[16:19], s61 offen sc1
    v_mfma_f32_32x32x16_bf16 v[64:79], v[140:143], v[108:111], v[64:79]
    v_mfma_f32_32x32x16_bf16 v[48:63], v[140:143], v[104:107], v[48:63]
    v_mfma_f32_32x32x16_bf16 v[32:47], v[136:139], v[108:111], v[32:47]
    v_mfma_f32_32x32x16_bf16 v[16:31], v[136:139], v[104:107], v[16:31]
    s_add_u32 s61, s68, 4096
    buffer_load_dwordx4 v[136:139], v10, s[16:19], s61 offen sc1
    buffer_load_dwordx4 v[140:143], v11, s[16:19], s61 offen sc1
    s_waitcnt vmcnt(12)
    v_mfma_f32_32x32x16_bf16 v[64:79], v[148:151], v[116:119], v[64:79]
    v_mfma_f32_32x32x16_bf16 v[48:63], v[148:151], v[112:115], v[48:63]
    v_mfma_f32_32x32x16_bf16 v[32:47], v[144:147], v[116:119], v[32:47]
    v_mfma_f32_32x32x16_bf16 v[16:31], v[144:147], v[112:115], v[16:31]
    s_add_u32 s61, s69, 2048
    buffer_load_dwordx4 v[104:107], v10, s[16:19], s61 offen sc1
    buffer_load_dwordx4 v[108:111], v11, s[16:19], s61 offen sc1
    s_waitcnt vmcnt(12)
    v_mfma_f32_32x32x16_bf16 v[64:79], v[156:159], v[84:87], v[64:79]
    v_mfma_f32_32x32x16_bf16 v[48:63], v[156:159], v[80:83], v[48:63]
    v_mfma_f32_32x32x16_bf16 v[32:47], v[152:155], v[84:87], v[32:47]
    v_mfma_f32_32x32x16_bf16 v[16:31], v[152:155], v[80:83], v[16:31]
    s_add_u32 s61, s69, 3072
    buffer_load_dwordx4 v[144:147], v10, s[16:19], s61 offen sc1
    buffer_load_dwordx4 v[148:151], v11, s[16:19], s61 offen sc1
    s_waitcnt vmcnt(12)
    v_mfma_f32_32x32x16_bf16 v[64:79], v[164:167], v[124:127], v[64:79]
    v_mfma_f32_32x32x16_bf16 v[48:63], v[164:167], v[120:123], v[48:63]
    v_mfma_f32_32x32x16_bf16 v[32:47], v[160:163], v[124:127], v[32:47]
    v_mfma_f32_32x32x16_bf16 v[16:31], v[160:163], v[120:123], v[16:31]
    s_add_u32 s61, s69, 4096
    buffer_load_dwordx4 v[112:115], v10, s[16:19], s61 offen sc1
    buffer_load_dwordx4 v[116:119], v11, s[16:19], s61 offen sc1
    s_waitcnt vmcnt(12)
    v_mfma_f32_32x32x16_bf16 v[64:79], v[172:175], v[92:95], v[64:79]
    v_mfma_f32_32x32x16_bf16 v[48:63], v[172:175], v[88:91], v[48:63]
    v_mfma_f32_32x32x16_bf16 v[32:47], v[168:171], v[92:95], v[32:47]
    v_mfma_f32_32x32x16_bf16 v[16:31], v[168:171], v[88:91], v[16:31]
    s_add_u32 s61, s70, 2048
    buffer_load_dwordx4 v[152:155], v10, s[16:19], s61 offen sc1
    buffer_load_dwordx4 v[156:159], v11, s[16:19], s61 offen sc1
    s_waitcnt vmcnt(12)
    v_mfma_f32_32x32x16_bf16 v[64:79], v[180:183], v[132:135], v[64:79]
    v_mfma_f32_32x32x16_bf16 v[48:63], v[180:183], v[128:131], v[48:63]
    v_mfma_f32_32x32x16_bf16 v[32:47], v[176:179], v[132:135], v[32:47]
    v_mfma_f32_32x32x16_bf16 v[16:31], v[176:179], v[128:131], v[16:31]
    s_add_u32 s61, s70, 3072
    buffer_load_dwordx4 v[80:83], v10, s[16:19], s61 offen sc1
    buffer_load_dwordx4 v[84:87], v11, s[16:19], s61 offen sc1
    s_waitcnt vmcnt(12)
    v_mfma_f32_32x32x16_bf16 v[64:79], v[188:191], v[100:103], v[64:79]
    v_mfma_f32_32x32x16_bf16 v[48:63], v[188:191], v[96:99], v[48:63]
    v_mfma_f32_32x32x16_bf16 v[32:47], v[184:187], v[100:103], v[32:47]
    v_mfma_f32_32x32x16_bf16 v[16:31], v[184:187], v[96:99], v[16:31]
    s_add_u32 s65, s59, 32768
    buffer_load_dword v2, v13, s[16:19], s65 offen sc1
    s_add_u32 s61, s70, 4096
    buffer_load_dwordx4 v[160:163], v10, s[16:19], s61 offen sc1
    buffer_load_dwordx4 v[164:167], v11, s[16:19], s61 offen sc1
    s_waitcnt vmcnt(13)
    v_mfma_f32_32x32x16_bf16 v[64:79], v[196:199], v[140:143], v[64:79]
    v_mfma_f32_32x32x16_bf16 v[48:63], v[196:199], v[136:139], v[48:63]
    v_mfma_f32_32x32x16_bf16 v[32:47], v[192:195], v[140:143], v[32:47]
    v_mfma_f32_32x32x16_bf16 v[16:31], v[192:195], v[136:139], v[16:31]
    s_add_u32 s61, s71, 2048
    buffer_load_dwordx4 v[120:123], v10, s[16:19], s61 offen sc1
    buffer_load_dwordx4 v[124:127], v11, s[16:19], s61 offen sc1
    s_waitcnt vmcnt(13)
    v_mfma_f32_32x32x16_bf16 v[64:79], v[204:207], v[108:111], v[64:79]
    v_mfma_f32_32x32x16_bf16 v[48:63], v[204:207], v[104:107], v[48:63]
    v_mfma_f32_32x32x16_bf16 v[32:47], v[200:203], v[108:111], v[32:47]
    v_mfma_f32_32x32x16_bf16 v[16:31], v[200:203], v[104:107], v[16:31]
    s_add_u32 s61, s71, 3072
    buffer_load_dwordx4 v[168:171], v10, s[16:19], s61 offen sc1
    buffer_load_dwordx4 v[172:175], v11, s[16:19], s61 offen sc1
    s_waitcnt vmcnt(13)
    v_mfma_f32_32x32x16_bf16 v[64:79], v[212:215], v[148:151], v[64:79]
    v_mfma_f32_32x32x16_bf16 v[48:63], v[212:215], v[144:147], v[48:63]
    v_mfma_f32_32x32x16_bf16 v[32:47], v[208:211], v[148:151], v[32:47]
    v_mfma_f32_32x32x16_bf16 v[16:31], v[208:211], v[144:147], v[16:31]
    s_add_u32 s61, s71, 4096
    buffer_load_dwordx4 v[88:91], v10, s[16:19], s61 offen sc1
    buffer_load_dwordx4 v[92:95], v11, s[16:19], s61 offen sc1
    s_waitcnt vmcnt(13)
    v_mfma_f32_32x32x16_bf16 v[64:79], v[220:223], v[116:119], v[64:79]
    v_mfma_f32_32x32x16_bf16 v[48:63], v[220:223], v[112:115], v[48:63]
    v_mfma_f32_32x32x16_bf16 v[32:47], v[216:219], v[116:119], v[32:47]
    v_mfma_f32_32x32x16_bf16 v[16:31], v[216:219], v[112:115], v[16:31]
    s_waitcnt vmcnt(8)
    v_cmp_eq_u32 vcc, 0, v2
    s_cbranch_vccnz ff_poll2
ff_rdy2:
    s_add_u32 s65, s59, 49152
    buffer_load_dword v2, v13, s[16:19], s65 offen sc1
    s_add_u32 s61, s68, 5120
    buffer_load_dwordx4 v[176:179], v10, s[16:19], s61 offen sc1
    buffer_load_dwordx4 v[180:183], v11, s[16:19], s61 offen sc1
    v_mfma_f32_32x32x16_bf16 v[64:79], v[228:231], v[156:159], v[64:79]
    v_mfma_f32_32x32x16_bf16 v[48:63], v[228:231], v[152:155], v[48:63]
    v_mfma_f32_32x32x16_bf16 v[32:47], v[224:227], v[156:159], v[32:47]
    v_mfma_f32_32x32x16_bf16 v[16:31], v[224:227], v[152:155], v[16:31]
    ds_read_b128 v[128:131], v12 offset:0
    ds_read_b128 v[132:135], v12 offset:1024
    s_add_u32 s61, s69, 5120
    buffer_load_dwordx4 v[184:187], v10, s[16:19], s61 offen sc1
    buffer_load_dwordx4 v[188:191], v11, s[16:19], s61 offen sc1
    v_mfma_f32_32x32x16_bf16 v[64:79], v[236:239], v[84:87], v[64:79]
    v_mfma_f32_32x32x16_bf16 v[48:63], v[236:239], v[80:83], v[48:63]
    v_mfma_f32_32x32x16_bf16 v[32:47], v[232:235], v[84:87], v[32:47]
    v_mfma_f32_32x32x16_bf16 v[16:31], v[232:235], v[80:83], v[16:31]
    ds_read_b128 v[96:99], v12 offset:2048
    ds_read_b128 v[100:103], v12 offset:3072
    s_add_u32 s61, s70, 5120
    buffer_load_dwordx4 v[192:195], v10, s[16:19], s61 offen sc1
    buffer_load_dwordx4 v[196:199], v11, s[16:19], s61 offen sc1
    s_waitcnt vmcnt(13)
    v_mfma_f32_32x32x16_bf16 v[64:79], v[244:247], v[164:167], v[64:79]
    v_mfma_f32_32x32x16_bf16 v[48:63], v[244:247], v[160:163], v[48:63]
    v_mfma_f32_32x32x16_bf16 v[32:47], v[240:243], v[164:167], v[32:47]
    v_mfma_f32_32x32x16_bf16 v[16:31], v[240:243], v[160:163], v[16:31]
    ds_read_b128 v[136:139], v12 offset:4096
    ds_read_b128 v[140:143], v12 offset:5120
    s_add_u32 s61, s71, 5120
    buffer_load_dwordx4 v[200:203], v10, s[16:19], s61 offen sc1
    buffer_load_dwordx4 v[204:207], v11, s[16:19], s61 offen sc1
    s_waitcnt vmcnt(13)
    v_mfma_f32_32x32x16_bf16 v[64:79], v[252:255], v[124:127], v[64:79]
    v_mfma_f32_32x32x16_bf16 v[48:63], v[252:255], v[120:123], v[48:63]
    v_mfma_f32_32x32x16_bf16 v[32:47], v[248:251], v[124:127], v[32:47]
    v_mfma_f32_32x32x16_bf16 v[16:31], v[248:251], v[120:123], v[16:31]
    ds_read_b128 v[104:107], v12 offset:6144
    ds_read_b128 v[108:111], v12 offset:7168
    s_waitcnt vmcnt(8)
    v_cmp_eq_u32 vcc, 0, v2
    s_cbranch_vccnz ff_poll3
ff_rdy3:
    s_add_u32 s61, s68, 6144
    buffer_load_dwordx4 v[208:211], v10, s[16:19], s61 offen sc1
    buffer_load_dwordx4 v[212:215], v11, s[16:19], s61 offen sc1
    s_waitcnt lgkmcnt(6)
    v_mfma_f32_32x32x16_bf16 v[64:79], v[132:135], v[172:175], v[64:79]
    v_mfma_f32_32x32x16_bf16 v[48:63], v[132:135], v[168:171], v[48:63]
    v_mfma_f32_32x32x16_bf16 v[32:47], v[128:131], v[172:175], v[32:47]
    v_mfma_f32_32x32x16_bf16 v[16:31], v[128:131], v[168:171], v[16:31]
    ds_read_b128 v[144:147], v12 offset:8192
    ds_read_b128 v[148:151], v12 offset:9216
    s_add_u32 s61, s69, 6144
    buffer_load_dwordx4 v[216:219], v10, s[16:19], s61 offen sc1
    buffer_load_dwordx4 v[220:223], v11, s[16:19], s61 offen sc1
    s_waitcnt lgkmcnt(6)
    v_mfma_f32_32x32x16_bf16 v[64:79], v[100:103], v[92:95], v[64:79]
    v_mfma_f32_32x32x16_bf16 v[48:63], v[100:103], v[88:91], v[48:63]
    v_mfma_f32_32x32x16_bf16 v[32:47], v[96:99], v[92:95], v[32:47]
    v_mfma_f32_32x32x16_bf16 v[16:31], v[96:99], v[88:91], v[16:31]
    ds_read_b128 v[112:115], v12 offset:10240
    ds_read_b128 v[116:119], v12 offset:11264
    s_add_u32 s61, s70, 6144
    buffer_load_dwordx4 v[224:227], v10, s[16:19], s61 offen sc1
    buffer_load_dwordx4 v[228:231], v11, s[16:19], s61 offen sc1
    s_waitcnt vmcnt(12)
    s_waitcnt lgkmcnt(6)
    v_mfma_f32_32x32x16_bf16 v[64:79], v[140:143], v[180:183], v[64:79]
    v_mfma_f32_32x32x16_bf16 v[48:63], v[140:143], v[176:179], v[48:63]
    v_mfma_f32_32x32x16_bf16 v[32:47], v[136:139], v[180:183], v[32:47]
    v_mfma_f32_32x32x16_bf16 v[16:31], v[136:139], v[176:179], v[16:31]
    v_add_u32 v12, s78, v12
    ds_read_b128 v[152:155], v12 offset:0
    ds_read_b128 v[156:159], v12 offset:1024
    s_add_u32 s61, s71, 6144
    buffer_load_dwordx4 v[232:235], v10, s[16:19], s61 offen sc1
    buffer_load_dwordx4 v[236:239], v11, s[16:19], s61 offen sc1
    s_waitcnt vmcnt(12)
    s_waitcnt lgkmcnt(6)
    v_mfma_f32_32x32x16_bf16 v[64:79], v[108:111], v[188:191], v[64:79]
    v_mfma_f32_32x32x16_bf16 v[48:63], v[108:111], v[184:187], v[48:63]
    v_mfma_f32_32x32x16_bf16 v[32:47], v[104:107], v[188:191], v[32:47]
    v_mfma_f32_32x32x16_bf16 v[16:31], v[104:107], v[184:187], v[16:31]
    ds_read_b128 v[80:83], v12 offset:2048
    ds_read_b128 v[84:87], v12 offset:3072
    s_waitcnt vmcnt(10)
    s_waitcnt lgkmcnt(6)
    v_mfma_f32_32x32x16_bf16 v[64:79], v[148:151], v[196:199], v[64:79]
    v_mfma_f32_32x32x16_bf16 v[48:63], v[148:151], v[192:195], v[48:63]
    v_mfma_f32_32x32x16_bf16 v[32:47], v[144:147], v[196:199], v[32:47]
    v_mfma_f32_32x32x16_bf16 v[16:31], v[144:147], v[192:195], v[16:31]
    ds_read_b128 v[240:243], v12 offset:4096
    ds_read_b128 v[244:247], v12 offset:5120
    s_barrier
    ds_read_b64_tr_b16 v[160:161], v14 offset:0
    ds_read_b64_tr_b16 v[162:163], v14 offset:1024
    ds_read_b64_tr_b16 v[164:165], v14 offset:2048
    ds_read_b64_tr_b16 v[166:167], v14 offset:3072
    s_waitcnt vmcnt(8)
    s_waitcnt lgkmcnt(10)
    v_mfma_f32_32x32x16_bf16 v[64:79], v[116:119], v[204:207], v[64:79]
    v_mfma_f32_32x32x16_bf16 v[48:63], v[116:119], v[200:203], v[48:63]
    v_mfma_f32_32x32x16_bf16 v[32:47], v[112:115], v[204:207], v[32:47]
    v_mfma_f32_32x32x16_bf16 v[16:31], v[112:115], v[200:203], v[16:31]
    ds_read_b128 v[248:251], v12 offset:6144
    ds_read_b128 v[252:255], v12 offset:7168
    s_waitcnt vmcnt(6)
    s_waitcnt lgkmcnt(10)
    v_mfma_f32_32x32x16_bf16 v[64:79], v[156:159], v[212:215], v[64:79]
    v_mfma_f32_32x32x16_bf16 v[48:63], v[156:159], v[208:211], v[48:63]
    v_mfma_f32_32x32x16_bf16 v[32:47], v[152:155], v[212:215], v[32:47]
    v_mfma_f32_32x32x16_bf16 v[16:31], v[152:155], v[208:211], v[16:31]
    s_waitcnt vmcnt(4)
    s_waitcnt lgkmcnt(8)
    v_mfma_f32_32x32x16_bf16 v[64:79], v[84:87], v[220:223], v[64:79]
    v_mfma_f32_32x32x16_bf16 v[48:63], v[84:87], v[216:219], v[48:63]
    v_mfma_f32_32x32x16_bf16 v[32:47], v[80:83], v[220:223], v[32:47]
    v_mfma_f32_32x32x16_bf16 v[16:31], v[80:83], v[216:219], v[16:31]
    s_waitcnt lgkmcnt(2)
    v_lshlrev_b32 v80, 16, v160
    v_and_b32 v81, s63, v160
    v_lshlrev_b32 v82, 16, v161
    v_and_b32 v83, s63, v161
    v_lshlrev_b32 v84, 16, v162
    v_and_b32 v85, s63, v162
    v_lshlrev_b32 v86, 16, v163
    v_and_b32 v87, s63, v163
    v_lshlrev_b32 v88, 16, v164
    v_and_b32 v89, s63, v164
    v_lshlrev_b32 v90, 16, v165
    v_and_b32 v91, s63, v165
    v_lshlrev_b32 v92, 16, v166
    v_and_b32 v93, s63, v166
    v_lshlrev_b32 v94, 16, v167
    v_and_b32 v95, s63, v167
    s_waitcnt vmcnt(2)
    v_mfma_f32_32x32x16_bf16 v[64:79], v[244:247], v[228:231], v[64:79]
    v_mfma_f32_32x32x16_bf16 v[48:63], v[244:247], v[224:227], v[48:63]
    v_mfma_f32_32x32x16_bf16 v[32:47], v[240:243], v[228:231], v[32:47]
    v_mfma_f32_32x32x16_bf16 v[16:31], v[240:243], v[224:227], v[16:31]
    s_waitcnt vmcnt(0)
    s_waitcnt lgkmcnt(0)
    v_mfma_f32_32x32x16_bf16 v[64:79], v[252:255], v[236:239], v[64:79]
    v_mfma_f32_32x32x16_bf16 v[48:63], v[252:255], v[232:235], v[48:63]
    v_mfma_f32_32x32x16_bf16 v[32:47], v[248:251], v[236:239], v[32:47]
    v_mfma_f32_32x32x16_bf16 v[16:31], v[248:251], v[232:235], v[16:31]
    s_nop 8
    ds_write_b128 v6, v[64:67] offset:40960
    ds_write_b128 v6, v[68:71] offset:41984
    ds_write_b128 v5, v[48:51] offset:36864
    ds_write_b128 v5, v[52:55] offset:37888
    ds_write_b128 v4, v[32:35] offset:32768
    ds_write_b128 v4, v[36:39] offset:33792
    ds_write_b128 v6, v[72:75] offset:43008
    ds_write_b128 v6, v[76:79] offset:44032
    ds_write_b128 v5, v[56:59] offset:38912
    ds_write_b128 v5, v[60:63] offset:39936
    ds_write_b128 v4, v[40:43] offset:34816
    ds_write_b128 v4, v[44:47] offset:35840
    v_pk_add_f32 v[80:81], v[80:81], v[16:17]
    v_pk_add_f32 v[82:83], v[82:83], v[18:19]
    v_pk_add_f32 v[84:85], v[84:85], v[20:21]
    v_pk_add_f32 v[86:87], v[86:87], v[22:23]
    v_pk_add_f32 v[88:89], v[88:89], v[24:25]
    v_pk_add_f32 v[90:91], v[90:91], v[26:27]
    v_pk_add_f32 v[92:93], v[92:93], v[28:29]
    v_pk_add_f32 v[94:95], v[94:95], v[30:31]
    s_waitcnt lgkmcnt(6)
    s_barrier
    ds_read_b128 v[32:35], v7 offset:32768
    ds_read_b128 v[48:51], v7 offset:36864
    ds_read_b128 v[64:67], v7 offset:40960
    ds_read_b128 v[36:39], v7 offset:33792
    ds_read_b128 v[52:55], v7 offset:37888
    ds_read_b128 v[68:71], v7 offset:41984
    s_waitcnt lgkmcnt(6)
    s_barrier
    ds_read_b128 v[40:43], v7 offset:34816
    ds_read_b128 v[56:59], v7 offset:38912
    ds_read_b128 v[72:75], v7 offset:43008
    ds_read_b128 v[44:47], v7 offset:35840
    ds_read_b128 v[60:63], v7 offset:39936
    ds_read_b128 v[76:79], v7 offset:44032
    s_waitcnt lgkmcnt(9)
    v_pk_add_f32 v[80:81], v[80:81], v[32:33]
    v_pk_add_f32 v[48:49], v[48:49], v[64:65]
    v_pk_add_f32 v[82:83], v[82:83], v[34:35]
    v_pk_add_f32 v[50:51], v[50:51], v[66:67]
    v_pk_add_f32 v[80:81], v[80:81], v[48:49]
    v_pk_add_f32 v[82:83], v[82:83], v[50:51]
    v_cvt_pk_bf16_f32 v16, v80, v81
    v_cvt_pk_bf16_f32 v17, v82, v83
    s_waitcnt lgkmcnt(6)
    v_pk_add_f32 v[84:85], v[84:85], v[36:37]
    v_pk_add_f32 v[52:53], v[52:53], v[68:69]
    v_pk_add_f32 v[86:87], v[86:87], v[38:39]
    v_pk_add_f32 v[54:55], v[54:55], v[70:71]
    v_pk_add_f32 v[84:85], v[84:85], v[52:53]
    v_pk_add_f32 v[86:87], v[86:87], v[54:55]
    v_cvt_pk_bf16_f32 v18, v84, v85
    v_cvt_pk_bf16_f32 v19, v86, v87
    s_nop 0
    v_permlane32_swap_b32 v16, v18
    v_permlane32_swap_b32 v17, v19
    buffer_store_dwordx4 v[16:19], v15, s[40:43], s62 offen offset:0
    s_waitcnt lgkmcnt(3)
    v_pk_add_f32 v[88:89], v[88:89], v[40:41]
    v_pk_add_f32 v[56:57], v[56:57], v[72:73]
    v_pk_add_f32 v[90:91], v[90:91], v[42:43]
    v_pk_add_f32 v[58:59], v[58:59], v[74:75]
    v_pk_add_f32 v[88:89], v[88:89], v[56:57]
    v_pk_add_f32 v[90:91], v[90:91], v[58:59]
    v_cvt_pk_bf16_f32 v20, v88, v89
    v_cvt_pk_bf16_f32 v21, v90, v91
    s_waitcnt lgkmcnt(0)
    v_pk_add_f32 v[92:93], v[92:93], v[44:45]
    v_pk_add_f32 v[60:61], v[60:61], v[76:77]
    v_pk_add_f32 v[94:95], v[94:95], v[46:47]
    v_pk_add_f32 v[62:63], v[62:63], v[78:79]
    v_pk_add_f32 v[92:93], v[92:93], v[60:61]
    v_pk_add_f32 v[94:95], v[94:95], v[62:63]
    v_cvt_pk_bf16_f32 v22, v92, v93
    v_cvt_pk_bf16_f32 v23, v94, v95
    s_nop 0
    v_permlane32_swap_b32 v20, v22
    v_permlane32_swap_b32 v21, v23
    buffer_store_dwordx4 v[20:23], v15, s[40:43], s62 offen offset:32
ff_end:
    s_endpgm
ff_poll0:
    s_add_u32 s65, s59, 0
    buffer_load_dword v2, v13, s[16:19], s65 offen sc1
    s_add_u32 s60, s60, 1
    s_waitcnt vmcnt(0)
    v_cmp_eq_u32 vcc, 0, v2
    s_cbranch_vccz ff_rdy0
    s_cmp_lt_u32 s60, 0x40000
    s_sleep 2
    s_cbranch_scc1 ff_poll0
    s_branch ff_rdy0
ff_poll1:
    s_add_u32 s65, s59, 16384
    buffer_load_dword v2, v13, s[16:19], s65 offen sc1
    s_add_u32 s60, s60, 1
    s_waitcnt vmcnt(0)
    v_cmp_eq_u32 vcc, 0, v2
    s_cbranch_vccz ff_rdy1
    s_cmp_lt_u32 s60, 0x40000
    s_sleep 2
    s_cbranch_scc1 ff_poll1
    s_branch ff_rdy1
ff_poll2:
    s_add_u32 s65, s59, 32768
    buffer_load_dword v2, v13, s[16:19], s65 offen sc1
    s_add_u32 s60, s60, 1
    s_waitcnt vmcnt(0)
    v_cmp_eq_u32 vcc, 0, v2
    s_cbranch_vccz ff_rdy2
    s_cmp_lt_u32 s60, 0x40000
    s_sleep 2
    s_cbranch_scc1 ff_poll2
    s_branch ff_rdy2
ff_poll3:
    s_add_u32 s65, s59, 49152
    buffer_load_dword v2, v13, s[16:19], s65 offen sc1
    s_add_u32 s60, s60, 1
    s_waitcnt vmcnt(0)
    v_cmp_eq_u32 vcc, 0, v2
    s_cbranch_vccz ff_rdy3
    s_cmp_lt_u32 s60, 0x40000
    s_sleep 2
    s_cbranch_scc1 ff_poll3
    s_branch ff_rdy3
code_end:
.section .rodata,"a"
.p2align 6
.amdhsa_kernel prep_kernel
  .amdhsa_next_free_vgpr 128
  .amdhsa_next_free_sgpr 102
  .amdhsa_accum_offset 128
  .amdhsa_group_segment_fixed_size 0
  .amdhsa_kernarg_size 104
  .amdhsa_user_sgpr_count 2
  .amdhsa_user_sgpr_kernarg_segment_ptr 1
  .amdhsa_system_sgpr_workgroup_id_x 1
  .amdhsa_float_denorm_mode_32 3
.end_amdhsa_kernel
.p2align 6
.amdhsa_kernel conv_kernel
  .amdhsa_next_free_vgpr 252
  .amdhsa_next_free_sgpr 102
  .amdhsa_accum_offset 252
  .amdhsa_group_segment_fixed_size 0
  .amdhsa_kernarg_size 104
  .amdhsa_user_sgpr_count 2
  .amdhsa_user_sgpr_kernarg_segment_ptr 1
  .amdhsa_system_sgpr_workgroup_id_x 1
  .amdhsa_float_denorm_mode_32 3
.end_amdhsa_kernel
.p2align 6
.amdhsa_kernel ffn_kernel
  .amdhsa_next_free_vgpr 256
  .amdhsa_next_free_sgpr 102
  .amdhsa_accum_offset 256
  .amdhsa_group_segment_fixed_size 0
  .amdhsa_kernarg_size 104
  .amdhsa_user_sgpr_count 2
  .amdhsa_user_sgpr_kernarg_segment_ptr 1
  .amdhsa_system_sgpr_workgroup_id_x 1
  .amdhsa_float_denorm_mode_32 3
.end_amdhsa_kernel
```
